```python
import torch

def _softmax(x, axis=-1):
    return torch.softmax(x, dim=axis)
def _gelu(x):
    return torch.nn.functional.gelu(x, approximate="tanh")
def _silu(x):
    return torch.nn.functional.silu(x)
def _sigmoid(x):
    return torch.sigmoid(x)
def _layernorm(x, axis=-1, eps=1e-5):
    m = x.mean(dim=axis, keepdim=True)
    v = x.var(dim=axis, keepdim=True, unbiased=False)
    return (x - m) / torch.sqrt(v + eps)
def _scatter_add(tgt, idx, src, axis=0):
    return tgt.clone().index_add_(axis, idx, src)
def _segment_sum(src, seg, n):
    out = torch.zeros((n,) + src.shape[1:], dtype=src.dtype)
    return out.index_add_(0, seg, src)
def _pad(x, pw):
    flat = tuple(v for pair in reversed(pw) for v in pair)
    return torch.nn.functional.pad(x, flat)

kernel_name = 'sequential_preLN__compressed_kv_cla__swiglu_ffn__decode'

def setup_inputs():

    _w = (lambda a: (lambda t: t.to(torch.bfloat16) if t.is_floating_point() else t)(torch.as_tensor(a)))
    def _A_setup():
        B, H, Sq, Sk, D, M = 2, 32, 1, 16384, 128, 576
        Dc = 4 * D
        return {
            "x": _w((lambda *s: torch.randn(*s, dtype=torch.bfloat16) * 0.05)(B, Sq, M)),
            "c_kv": _w((lambda *s: torch.randn(*s, dtype=torch.bfloat16) * 0.4)(B, Sk, Dc)),
            "w_q": _w((lambda *s: torch.randn(*s, dtype=torch.bfloat16) * 3.2)(M, H, D) * (M ** -0.5)),
            "w_uk": _w((lambda *s: torch.randn(*s, dtype=torch.bfloat16) * 3.2)(Dc, H, D) * (Dc ** -0.5)),
            "w_uv": _w((lambda *s: torch.randn(*s, dtype=torch.bfloat16) * 0.4)(Dc, H, D) * (Dc ** -0.5)),
            "w_o": _w((lambda *s: torch.randn(*s, dtype=torch.bfloat16) * 0.4)(H, D, M) * ((H * D) ** -0.5)),
        }
    _A_in = _A_setup()

    def _B_setup():
        B, S, D, F = 2, 1, 576, 4608
        return {
            "x": _w((lambda *s: torch.randn(*s, dtype=torch.bfloat16) * 0.05)(B, S, D)),
            "w_gate": _w((lambda *s: torch.randn(*s, dtype=torch.bfloat16) * 0.05)(D, F)),
            "w_up": _w((lambda *s: torch.randn(*s, dtype=torch.bfloat16) * 0.05)(D, F)),
            "w_down": _w((lambda *s: torch.randn(*s, dtype=torch.bfloat16) * 0.05)(F, D)),
        }
    _B_in = _B_setup()

    return {
        "A_x": _A_in["x"],
        "A_c_kv": _A_in["c_kv"],
        "A_w_q": _A_in["w_q"],
        "A_w_uk": _A_in["w_uk"],
        "A_w_uv": _A_in["w_uv"],
        "A_w_o": _A_in["w_o"],
        "B_x": _B_in["x"],
        "B_w_gate": _B_in["w_gate"],
        "B_w_up": _B_in["w_up"],
        "B_w_down": _B_in["w_down"],
    }

def reference(A_x, A_c_kv, A_w_q, A_w_uk, A_w_uv, A_w_o, B_x, B_w_gate, B_w_up, B_w_down):
    def _A_ref(x, c_kv, w_q, w_uk, w_uv, w_o):
        B, Sq, M = x.shape[0], x.shape[1], x.shape[2]
        Sk = c_kv.shape[1]
        H, D = w_q.shape[1], w_q.shape[2]
        q = torch.einsum("bqm,mhd->bhqd", x, w_q)
        k = torch.einsum("bkc,chd->bhkd", c_kv, w_uk)
        v = torch.einsum("bkc,chd->bhkd", c_kv, w_uv)
        scores = torch.einsum("bhqd,bhkd->bhqk", q, k) * (D ** -0.5)
        off = Sk - Sq
        qi = torch.arange(Sq)[:, None]
        kj = torch.arange(Sk)[None, :]
        cmask = kj <= (qi + off)
        scores = torch.where(cmask[None, None], scores, -1e9)
        p = _softmax(scores, axis=-1)
        ctx = torch.einsum("bhqk,bhkd->bhqd", p, v)
        return torch.einsum("bhqd,hdm->bqm", ctx, w_o)

    def _B_ref(x, w_gate, w_up, w_down):
        g = _silu(x @ w_gate)
        u = x @ w_up
        return (g * u) @ w_down

    x = A_x
    h = x + _A_ref(_layernorm(x, axis=-1), A_c_kv, A_w_q, A_w_uk, A_w_uv, A_w_o)
    h2 = h + _B_ref(_layernorm(h, axis=-1), B_w_gate, B_w_up, B_w_down)
    return h2
```

```asm
; @launch kernel=k1_kernel grid=(256,1,1) block=(512,1,1) lds=77056
; @launch kernel=k2_kernel grid=(256,1,1) block=(256,1,1) lds=163840
; @launch kernel=t_kernel grid=(256,1,1) block=(512,1,1) lds=145280
.amdgcn_target "amdgcn-amd-amdhsa--gfx950"
.text
.globl k1_kernel
.p2align 8
.type k1_kernel,@function
k1_kernel:
    s_cmp_ge_u32 s2, 256
    s_cbranch_scc1 K1_END
    s_load_dwordx2 s[4:5], s[0:1], 0
    s_load_dwordx2 s[6:7], s[0:1], 16
    s_load_dwordx2 s[8:9], s[0:1], 24
    s_load_dwordx2 s[10:11], s[0:1], 96
    v_and_b32 v1, 63, v0
    v_lshrrev_b32 v2, 6, v0
    s_nop 0
    v_readfirstlane_b32 s3, v2
    s_waitcnt lgkmcnt(0)
    s_mov_b32 s12, s4
    s_and_b32 s13, s5, 0xffff
    s_mov_b32 s14, 0x900
    s_mov_b32 s15, 0x20000
    s_mov_b32 s16, s6
    s_and_b32 s17, s7, 0xffff
    s_mov_b32 s18, 0x480000
    s_mov_b32 s19, 0x20000
    s_mov_b32 s20, s8
    s_and_b32 s21, s9, 0xffff
    s_mov_b32 s22, 0x400000
    s_mov_b32 s23, 0x20000
    s_mov_b32 s24, s10
    s_and_b32 s25, s11, 0xffff
    s_mov_b32 s26, 0x1000000
    s_mov_b32 s27, 0x20000
    s_and_b32 s28, s2, 31
    s_bfe_u32 s29, s2, 0x10005
    s_lshr_b32 s37, s2, 6
    v_cmp_gt_u32 s[44:45], 32, v1
    v_mov_b32 v14, 0
    s_sub_u32 s36, s3, 6
    s_mul_i32 s30, s36, 1152
    v_lshlrev_b32 v3, 2, v1
    s_cmp_lt_u32 s3, 6
    s_cbranch_scc1 K1_NOX_1
    buffer_load_dword v10, v3, s[12:15], s30 offen offset:0
    buffer_load_dword v11, v3, s[12:15], s30 offen offset:256
    buffer_load_dword v12, v3, s[12:15], s30 offen offset:512
    buffer_load_dword v13, v3, s[12:15], s30 offen offset:768
    s_mov_b64 s[42:43], exec
    s_mov_b64 exec, s[44:45]
    buffer_load_dword v14, v3, s[12:15], s30 offen offset:1024
    s_mov_b64 exec, s[42:43]
K1_NOX_1:
    v_lshrrev_b32 v4, 3, v1
    v_and_b32 v5, 7, v1
    v_add_u32 v6, 0, v4
    v_bfe_u32 v16, v6, 1, 1
    v_bfe_u32 v6, v6, 3, 1
    v_lshl_or_b32 v16, v6, 1, v16
    v_lshlrev_b32 v16, 1, v16
    v_xor_b32 v16, v16, v5
    v_lshlrev_b32 v16, 4, v16
    s_mov_b32 s50, 8192
    v_mul_lo_u32 v6, v4, s50
    v_add_u32 v16, v16, v6
    v_add_u32 v6, 8, v4
    v_bfe_u32 v17, v6, 1, 1
    v_bfe_u32 v6, v6, 3, 1
    v_lshl_or_b32 v17, v6, 1, v17
    v_lshlrev_b32 v17, 1, v17
    v_xor_b32 v17, v17, v5
    v_lshlrev_b32 v17, 4, v17
    s_mov_b32 s50, 8192
    v_mul_lo_u32 v6, v4, s50
    v_add_u32 v17, v17, v6
    s_bitcmp1_b32 s3, 0
    s_cselect_b64 s[46:47], -1, 0
    v_cndmask_b32 v18, v16, v17, s[46:47]
    v_cndmask_b32 v19, v17, v16, s[46:47]
    s_mul_i32 s31, s3, 9
    s_lshl_b32 s32, s31, 16
    s_lshl_b32 s33, s28, 8
    s_add_u32 s32, s32, s33
    s_lshl_b32 s33, s29, 7
    s_add_u32 s32, s32, s33
    s_lshl_b32 s33, s31, 10
    s_mov_b32 m0, s33
    s_nop 0
    buffer_load_dwordx4 v18, s[16:19], s32 offen lds
    s_add_u32 s32, s32, 65536
    s_add_u32 s33, s33, 1024
    s_mov_b32 m0, s33
    s_nop 0
    buffer_load_dwordx4 v19, s[16:19], s32 offen lds
    s_add_u32 s32, s32, 65536
    s_add_u32 s33, s33, 1024
    s_mov_b32 m0, s33
    s_nop 0
    buffer_load_dwordx4 v18, s[16:19], s32 offen lds
    s_add_u32 s32, s32, 65536
    s_add_u32 s33, s33, 1024
    s_mov_b32 m0, s33
    s_nop 0
    buffer_load_dwordx4 v19, s[16:19], s32 offen lds
    s_add_u32 s32, s32, 65536
    s_add_u32 s33, s33, 1024
    s_mov_b32 m0, s33
    s_nop 0
    buffer_load_dwordx4 v18, s[16:19], s32 offen lds
    s_add_u32 s32, s32, 65536
    s_add_u32 s33, s33, 1024
    s_mov_b32 m0, s33
    s_nop 0
    buffer_load_dwordx4 v19, s[16:19], s32 offen lds
    s_add_u32 s32, s32, 65536
    s_add_u32 s33, s33, 1024
    s_mov_b32 m0, s33
    s_nop 0
    buffer_load_dwordx4 v18, s[16:19], s32 offen lds
    s_add_u32 s32, s32, 65536
    s_add_u32 s33, s33, 1024
    s_mov_b32 m0, s33
    s_nop 0
    buffer_load_dwordx4 v19, s[16:19], s32 offen lds
    s_add_u32 s32, s32, 65536
    s_add_u32 s33, s33, 1024
    s_mov_b32 m0, s33
    s_nop 0
    buffer_load_dwordx4 v18, s[16:19], s32 offen lds
    s_add_u32 s32, s32, 65536
    s_add_u32 s33, s33, 1024
    s_lshl_b32 s33, s37, 7
    s_lshl_b32 s34, s3, 4
    s_add_u32 s33, s33, s34
    v_and_b32 v4, 15, v1
    v_add_u32 v4, s33, v4
    v_lshlrev_b32 v4, 13, v4
    v_lshrrev_b32 v5, 4, v1
    v_lshl_add_u32 v4, v5, 4, v4
    s_lshl_b32 s33, s28, 8
    s_lshl_b32 s34, s29, 7
    s_add_u32 s33, s33, s34
    buffer_load_dwordx4 v[120:123], v4, s[20:23], s33 offen offset:0 nt
    buffer_load_dwordx4 v[124:127], v4, s[20:23], s33 offen offset:64 nt
    s_cmp_lg_u32 s3, 0
    s_cbranch_scc1 K1_FILL_2
    v_mov_b32 v20, -1
    v_mov_b32 v21, -1
    v_mov_b32 v22, -1
    v_mov_b32 v23, -1
    v_lshlrev_b32 v9, 4, v1
    s_lshl_b32 s33, s2, 10
    s_add_u32 s34, s33, 0x40000
    buffer_store_dwordx4 v[20:23], v9, s[24:27], s34 offen
    s_add_u32 s34, s33, 0x80000
    buffer_store_dwordx4 v[20:23], v9, s[24:27], s34 offen
    s_mul_i32 s33, s2, 576
    s_mov_b32 s46, -1
    s_mov_b32 s47, 0xf
    s_mov_b64 exec, s[46:47]
    s_add_u32 s34, s33, 0xd0000
    buffer_store_dwordx4 v[20:23], v9, s[24:27], s34 offen
    s_add_u32 s34, s33, 0x100000
    buffer_store_dwordx4 v[20:23], v9, s[24:27], s34 offen
    s_lshl_b32 s33, s2, 5
    s_cmp_ge_u32 s2, 144
    s_cbranch_scc1 K1_FILL_2_r
    s_mov_b64 exec, 3
    s_add_u32 s34, s33, 0x10000
    buffer_store_dwordx4 v[20:23], v9, s[24:27], s34 offen
K1_FILL_2_r:
    s_mov_b64 exec, -1
K1_FILL_2:
    s_cmp_lt_u32 s3, 6
    s_cbranch_scc1 K1_NOLN_3
    s_waitcnt vmcnt(11)
    v_lshlrev_b32 v24, 16, v10
    v_and_b32 v25, 0xffff0000, v10
    v_lshlrev_b32 v26, 16, v11
    v_and_b32 v27, 0xffff0000, v11
    v_lshlrev_b32 v28, 16, v12
    v_and_b32 v29, 0xffff0000, v12
    v_lshlrev_b32 v30, 16, v13
    v_and_b32 v31, 0xffff0000, v13
    v_lshlrev_b32 v32, 16, v14
    v_and_b32 v33, 0xffff0000, v14
    v_add_f32 v40, v24, v25
    v_add_f32 v40, v40, v26
    v_add_f32 v40, v40, v27
    v_add_f32 v40, v40, v28
    v_add_f32 v40, v40, v29
    v_add_f32 v40, v40, v30
    v_add_f32 v40, v40, v31
    v_add_f32 v40, v40, v32
    v_add_f32 v40, v40, v33
    s_nop 1
    v_add_f32_dpp v40, v40, v40 row_shr:1 row_mask:0xf bank_mask:0xf
    s_nop 1
    v_add_f32_dpp v40, v40, v40 row_shr:2 row_mask:0xf bank_mask:0xf
    s_nop 1
    v_add_f32_dpp v40, v40, v40 row_shr:4 row_mask:0xf bank_mask:0xf
    s_nop 1
    v_add_f32_dpp v40, v40, v40 row_shr:8 row_mask:0xf bank_mask:0xf
    s_nop 1
    v_add_f32_dpp v40, v40, v40 row_bcast:15 row_mask:0xa bank_mask:0xf
    s_nop 1
    v_add_f32_dpp v40, v40, v40 row_bcast:31 row_mask:0xc bank_mask:0xf
    s_nop 1
    v_readlane_b32 s40, v40, 63
    s_nop 3
    v_mov_b32 v41, s40
    v_mul_f32 v41, 0x3ae38e39, v41
    v_mov_b32 v40, 0
    v_sub_f32 v43, v24, v41
    v_fmac_f32 v40, v43, v43
    v_sub_f32 v43, v25, v41
    v_fmac_f32 v40, v43, v43
    v_sub_f32 v43, v26, v41
    v_fmac_f32 v40, v43, v43
    v_sub_f32 v43, v27, v41
    v_fmac_f32 v40, v43, v43
    v_sub_f32 v43, v28, v41
    v_fmac_f32 v40, v43, v43
    v_sub_f32 v43, v29, v41
    v_fmac_f32 v40, v43, v43
    v_sub_f32 v43, v30, v41
    v_fmac_f32 v40, v43, v43
    v_sub_f32 v43, v31, v41
    v_fmac_f32 v40, v43, v43
    v_sub_f32 v43, v32, v41
    v_cndmask_b32 v43, 0, v43, s[44:45]
    v_fmac_f32 v40, v43, v43
    v_sub_f32 v43, v33, v41
    v_cndmask_b32 v43, 0, v43, s[44:45]
    v_fmac_f32 v40, v43, v43
    s_nop 1
    v_add_f32_dpp v40, v40, v40 row_shr:1 row_mask:0xf bank_mask:0xf
    s_nop 1
    v_add_f32_dpp v40, v40, v40 row_shr:2 row_mask:0xf bank_mask:0xf
    s_nop 1
    v_add_f32_dpp v40, v40, v40 row_shr:4 row_mask:0xf bank_mask:0xf
    s_nop 1
    v_add_f32_dpp v40, v40, v40 row_shr:8 row_mask:0xf bank_mask:0xf
    s_nop 1
    v_add_f32_dpp v40, v40, v40 row_bcast:15 row_mask:0xa bank_mask:0xf
    s_nop 1
    v_add_f32_dpp v40, v40, v40 row_bcast:31 row_mask:0xc bank_mask:0xf
    s_nop 1
    v_readlane_b32 s40, v40, 63
    s_nop 3
    v_mov_b32 v44, s40
    v_mul_f32 v44, 0x3ae38e39, v44
    v_cvt_pk_bf16_f32 v44, v44, v44
    v_and_b32 v44, 0xffff0000, v44
    v_add_f32 v44, 0x3727c5ac, v44
    v_cvt_pk_bf16_f32 v44, v44, v44
    v_and_b32 v44, 0xffff0000, v44
    v_sqrt_f32 v44, v44
    s_nop 0
    v_cvt_pk_bf16_f32 v44, v44, v44
    v_and_b32 v44, 0xffff0000, v44
    v_rcp_f32 v42, v44
    v_cvt_pk_bf16_f32 v41, v41, v41
    v_and_b32 v41, 0xffff0000, v41
    v_sub_f32 v43, v24, v41
    v_cvt_pk_bf16_f32 v43, v43, v43
    v_and_b32 v43, 0xffff0000, v43
    v_mul_f32 v45, v43, v42
    v_fma_f32 v24, -v45, v44, v43
    v_fma_f32 v24, v24, v42, v45
    v_sub_f32 v43, v25, v41
    v_cvt_pk_bf16_f32 v43, v43, v43
    v_and_b32 v43, 0xffff0000, v43
    v_mul_f32 v45, v43, v42
    v_fma_f32 v25, -v45, v44, v43
    v_fma_f32 v25, v25, v42, v45
    v_sub_f32 v43, v26, v41
    v_cvt_pk_bf16_f32 v43, v43, v43
    v_and_b32 v43, 0xffff0000, v43
    v_mul_f32 v45, v43, v42
    v_fma_f32 v26, -v45, v44, v43
    v_fma_f32 v26, v26, v42, v45
    v_sub_f32 v43, v27, v41
    v_cvt_pk_bf16_f32 v43, v43, v43
    v_and_b32 v43, 0xffff0000, v43
    v_mul_f32 v45, v43, v42
    v_fma_f32 v27, -v45, v44, v43
    v_fma_f32 v27, v27, v42, v45
    v_sub_f32 v43, v28, v41
    v_cvt_pk_bf16_f32 v43, v43, v43
    v_and_b32 v43, 0xffff0000, v43
    v_mul_f32 v45, v43, v42
    v_fma_f32 v28, -v45, v44, v43
    v_fma_f32 v28, v28, v42, v45
    v_sub_f32 v43, v29, v41
    v_cvt_pk_bf16_f32 v43, v43, v43
    v_and_b32 v43, 0xffff0000, v43
    v_mul_f32 v45, v43, v42
    v_fma_f32 v29, -v45, v44, v43
    v_fma_f32 v29, v29, v42, v45
    v_sub_f32 v43, v30, v41
    v_cvt_pk_bf16_f32 v43, v43, v43
    v_and_b32 v43, 0xffff0000, v43
    v_mul_f32 v45, v43, v42
    v_fma_f32 v30, -v45, v44, v43
    v_fma_f32 v30, v30, v42, v45
    v_sub_f32 v43, v31, v41
    v_cvt_pk_bf16_f32 v43, v43, v43
    v_and_b32 v43, 0xffff0000, v43
    v_mul_f32 v45, v43, v42
    v_fma_f32 v31, -v45, v44, v43
    v_fma_f32 v31, v31, v42, v45
    v_sub_f32 v43, v32, v41
    v_cvt_pk_bf16_f32 v43, v43, v43
    v_and_b32 v43, 0xffff0000, v43
    v_mul_f32 v45, v43, v42
    v_fma_f32 v32, -v45, v44, v43
    v_fma_f32 v32, v32, v42, v45
    v_sub_f32 v43, v33, v41
    v_cvt_pk_bf16_f32 v43, v43, v43
    v_and_b32 v43, 0xffff0000, v43
    v_mul_f32 v45, v43, v42
    v_fma_f32 v33, -v45, v44, v43
    v_fma_f32 v33, v33, v42, v45
    s_mul_i32 s33, s36, 1152
    s_add_u32 s33, s33, 73728
    v_lshl_add_u32 v9, v1, 2, s33
    v_cvt_pk_bf16_f32 v24, v24, v25
    v_cvt_pk_bf16_f32 v26, v26, v27
    v_cvt_pk_bf16_f32 v28, v28, v29
    v_cvt_pk_bf16_f32 v30, v30, v31
    v_cvt_pk_bf16_f32 v32, v32, v33
    ds_write_b32 v9, v24 offset:0
    ds_write_b32 v9, v26 offset:256
    ds_write_b32 v9, v28 offset:512
    ds_write_b32 v9, v30 offset:768
    s_mov_b64 s[42:43], exec
    s_mov_b64 exec, s[44:45]
    ds_write_b32 v9, v32 offset:1024
    s_mov_b64 exec, s[42:43]
K1_NOLN_3:
    s_and_b32 s31, s3, 3
    v_mov_b32 v8, s31
    v_lshrrev_b32 v4, 4, v1
    v_bfe_u32 v5, v1, 2, 2
    v_lshl_add_u32 v4, v4, 3, v5
    v_bfe_u32 v5, v4, 1, 1
    v_bfe_u32 v6, v4, 3, 1
    v_lshl_or_b32 v5, v6, 1, v5
    v_xor_b32 v5, v5, v8
    v_lshlrev_b32 v5, 5, v5
    s_mov_b32 s50, 128
    v_mul_lo_u32 v48, v4, s50
    v_add_u32 v48, v48, v5
    v_and_b32 v5, 3, v1
    v_lshl_add_u32 v48, v5, 3, v48
    v_add_u32 v4, 4, v4
    v_bfe_u32 v5, v4, 1, 1
    v_bfe_u32 v6, v4, 3, 1
    v_lshl_or_b32 v5, v6, 1, v5
    v_xor_b32 v5, v5, v8
    v_lshlrev_b32 v5, 5, v5
    s_mov_b32 s50, 128
    v_mul_lo_u32 v49, v4, s50
    v_add_u32 v49, v49, v5
    v_and_b32 v5, 3, v1
    v_lshl_add_u32 v49, v5, 3, v49
    v_and_b32 v50, 15, v1
    v_min_u32 v50, 1, v50
    s_mov_b32 s50, 1152
    v_mul_lo_u32 v50, v50, s50
    v_lshrrev_b32 v4, 4, v1
    v_lshl_add_u32 v50, v4, 4, v50
    v_add_u32 v50, 0x12000, v50
    s_lshr_b32 s32, s3, 2
    s_mul_i32 s33, s32, 36864
    v_add_u32 v48, s33, v48
    v_add_u32 v49, s33, v49
    s_mul_i32 s33, s32, 576
    v_add_u32 v50, s33, v50
    s_waitcnt vmcnt(0) lgkmcnt(0)
    s_barrier
    ds_read_b128 v[64:67], v50 offset:0
    ds_read_b64_tr_b16 v[96:97], v48 offset:0
    ds_read_b64_tr_b16 v[98:99], v49 offset:0
    ds_read_b128 v[68:71], v50 offset:64
    ds_read_b64_tr_b16 v[100:101], v48 offset:4096
    ds_read_b64_tr_b16 v[102:103], v49 offset:4096
    ds_read_b128 v[72:75], v50 offset:128
    ds_read_b64_tr_b16 v[104:105], v48 offset:8192
    ds_read_b64_tr_b16 v[106:107], v49 offset:8192
    ds_read_b128 v[76:79], v50 offset:192
    ds_read_b64_tr_b16 v[108:109], v48 offset:12288
    ds_read_b64_tr_b16 v[110:111], v49 offset:12288
    ds_read_b128 v[80:83], v50 offset:256
    ds_read_b64_tr_b16 v[112:113], v48 offset:16384
    ds_read_b64_tr_b16 v[114:115], v49 offset:16384
    s_waitcnt lgkmcnt(12)
    v_mfma_f32_16x16x32_bf16 v[52:55], v[64:67], v[96:99], 0
    s_waitcnt lgkmcnt(9)
    v_mfma_f32_16x16x32_bf16 v[52:55], v[68:71], v[100:103], v[52:55]
    s_waitcnt lgkmcnt(6)
    v_mfma_f32_16x16x32_bf16 v[52:55], v[72:75], v[104:107], v[52:55]
    s_waitcnt lgkmcnt(3)
    v_mfma_f32_16x16x32_bf16 v[52:55], v[76:79], v[108:111], v[52:55]
    s_waitcnt lgkmcnt(0)
    v_mfma_f32_16x16x32_bf16 v[52:55], v[80:83], v[112:115], v[52:55]
    ds_read_b128 v[64:67], v50 offset:320
    ds_read_b64_tr_b16 v[96:97], v48 offset:20480
    ds_read_b64_tr_b16 v[98:99], v49 offset:20480
    ds_read_b128 v[68:71], v50 offset:384
    ds_read_b64_tr_b16 v[100:101], v48 offset:24576
    ds_read_b64_tr_b16 v[102:103], v49 offset:24576
    ds_read_b128 v[72:75], v50 offset:448
    ds_read_b64_tr_b16 v[104:105], v48 offset:28672
    ds_read_b64_tr_b16 v[106:107], v49 offset:28672
    ds_read_b128 v[76:79], v50 offset:512
    ds_read_b64_tr_b16 v[108:109], v48 offset:32768
    ds_read_b64_tr_b16 v[110:111], v49 offset:32768
    s_waitcnt lgkmcnt(9)
    v_mfma_f32_16x16x32_bf16 v[52:55], v[64:67], v[96:99], v[52:55]
    s_waitcnt lgkmcnt(6)
    v_mfma_f32_16x16x32_bf16 v[52:55], v[68:71], v[100:103], v[52:55]
    s_waitcnt lgkmcnt(3)
    v_mfma_f32_16x16x32_bf16 v[52:55], v[72:75], v[104:107], v[52:55]
    s_waitcnt lgkmcnt(0)
    v_mfma_f32_16x16x32_bf16 v[52:55], v[76:79], v[108:111], v[52:55]
    s_nop 7
    s_lshl_b32 s33, s31, 6
    s_add_u32 s33, s33, 76544
    v_lshl_add_u32 v9, v1, 2, s33
    s_cmp_lt_u32 s3, 4
    s_cbranch_scc1 K1_H_4
    s_mov_b64 exec, 0xffff
    ds_write_b32 v9, v52
    ds_write_b32 v9, v53 offset:256
    s_mov_b64 exec, -1
K1_H_4:
    s_waitcnt lgkmcnt(0)
    s_barrier
    s_cmp_ge_u32 s3, 4
    s_cbranch_scc1 K1_H2_5
    s_mov_b64 exec, 0xffff
    ds_read_b32 v54, v9
    ds_read_b32 v55, v9 offset:256
    s_waitcnt lgkmcnt(0)
    v_add_f32 v52, v52, v54
    v_add_f32 v53, v53, v55
    v_cvt_pk_bf16_f32 v52, v52, v52
    v_cvt_pk_bf16_f32 v53, v53, v53
    s_lshl_b32 s33, s31, 5
    s_add_u32 s33, s33, 76032
    v_lshl_add_u32 v9, v1, 1, s33
    ds_write_b16 v9, v52
    ds_write_b16 v9, v53 offset:128
    s_mov_b64 exec, -1
K1_H2_5:
    s_waitcnt lgkmcnt(0)
    s_barrier
    v_and_b32 v50, 15, v1
    v_min_u32 v50, 1, v50
    s_mov_b32 s50, 128
    v_mul_lo_u32 v50, v50, s50
    v_lshrrev_b32 v4, 4, v1
    v_lshl_add_u32 v50, v4, 4, v50
    v_add_u32 v50, 0x12900, v50
    ds_read_b128 v[64:67], v50 offset:0
    ds_read_b128 v[68:71], v50 offset:64
    s_waitcnt lgkmcnt(1)
    v_mfma_f32_16x16x32_bf16 v[52:55], v[120:123], v[64:67], 0
    s_waitcnt lgkmcnt(0)
    v_mfma_f32_16x16x32_bf16 v[52:55], v[124:127], v[68:71], v[52:55]
    v_and_b32 v4, 15, v1
    v_lshlrev_b32 v9, 15, v4
    v_lshrrev_b32 v5, 5, v1
    v_lshl_add_u32 v9, v5, 9, v9
    v_bfe_u32 v5, v1, 4, 1
    v_lshl_add_u32 v9, v5, 3, v9
    s_lshl_b32 s33, s37, 3
    s_add_u32 s33, s33, s3
    s_lshl_b32 s33, s33, 10
    s_lshl_b32 s34, s28, 4
    s_add_u32 s33, s33, s34
    s_lshl_b32 s34, s29, 16
    s_add_u32 s33, s33, s34
    s_add_u32 s33, s33, 0x200000
    s_nop 2
    v_mul_f32 v52, 0x3e0293ee, v52
    v_mul_f32 v53, 0x3e0293ee, v53
    v_mul_f32 v54, 0x3e0293ee, v54
    v_mul_f32 v55, 0x3e0293ee, v55
    v_cvt_pk_bf16_f32 v52, v52, v53
    v_cvt_pk_bf16_f32 v53, v54, v55
    v_cmp_gt_u32 vcc, 2, v4
    s_and_saveexec_b64 s[42:43], vcc
    buffer_store_dwordx2 v[52:53], v9, s[24:27], s33 offen
    s_mov_b64 exec, s[42:43]
K1_END:
    s_endpgm
.globl k2_kernel
.p2align 8
.type k2_kernel,@function
k2_kernel:
    s_cmp_ge_u32 s2, 256
    s_cbranch_scc1 K2_END
    s_load_dwordx2 s[4:5], s[0:1], 8
    s_load_dwordx2 s[10:11], s[0:1], 96
    v_and_b32 v1, 63, v0
    v_lshrrev_b32 v2, 6, v0
    s_nop 0
    v_readfirstlane_b32 s3, v2
    s_waitcnt lgkmcnt(0)
    s_mov_b32 s12, s4
    s_and_b32 s13, s5, 0xffff
    s_mov_b32 s14, 0x2000000
    s_mov_b32 s15, 0x20000
    s_mov_b32 s24, s10
    s_and_b32 s25, s11, 0xffff
    s_mov_b32 s26, 0x1000000
    s_mov_b32 s27, 0x20000
    s_lshr_b32 s28, s2, 7
    s_and_b32 s29, s2, 127
    v_lshlrev_b32 v3, 4, v1
    s_lshl_b32 s30, s28, 15
    s_lshl_b32 s31, s3, 13
    s_add_u32 s30, s30, s31
    s_add_u32 s30, s30, 0x200000
    s_add_u32 s34, s30, 0
    buffer_load_dwordx4 v[128:131], v3, s[24:27], s34 offen offset:0
    buffer_load_dwordx4 v[132:135], v3, s[24:27], s34 offen offset:1024
    buffer_load_dwordx4 v[136:139], v3, s[24:27], s34 offen offset:2048
    buffer_load_dwordx4 v[140:143], v3, s[24:27], s34 offen offset:3072
    s_add_u32 s34, s30, 4096
    buffer_load_dwordx4 v[144:147], v3, s[24:27], s34 offen offset:0
    buffer_load_dwordx4 v[148:151], v3, s[24:27], s34 offen offset:1024
    buffer_load_dwordx4 v[152:155], v3, s[24:27], s34 offen offset:2048
    buffer_load_dwordx4 v[156:159], v3, s[24:27], s34 offen offset:3072
    s_add_u32 s34, s30, 65536
    buffer_load_dwordx4 v[160:163], v3, s[24:27], s34 offen offset:0
    buffer_load_dwordx4 v[164:167], v3, s[24:27], s34 offen offset:1024
    buffer_load_dwordx4 v[168:171], v3, s[24:27], s34 offen offset:2048
    buffer_load_dwordx4 v[172:175], v3, s[24:27], s34 offen offset:3072
    s_add_u32 s34, s30, 69632
    buffer_load_dwordx4 v[176:179], v3, s[24:27], s34 offen offset:0
    buffer_load_dwordx4 v[180:183], v3, s[24:27], s34 offen offset:1024
    buffer_load_dwordx4 v[184:187], v3, s[24:27], s34 offen offset:2048
    buffer_load_dwordx4 v[188:191], v3, s[24:27], s34 offen offset:3072
    v_xor_b32 v8, 0, v1
    v_lshlrev_b32 v8, 4, v8
    v_xor_b32 v9, 1, v1
    v_lshlrev_b32 v9, 4, v9
    v_xor_b32 v10, 2, v1
    v_lshlrev_b32 v10, 4, v10
    v_xor_b32 v11, 3, v1
    v_lshlrev_b32 v11, 4, v11
    v_xor_b32 v12, 4, v1
    v_lshlrev_b32 v12, 4, v12
    v_xor_b32 v13, 5, v1
    v_lshlrev_b32 v13, 4, v13
    v_xor_b32 v14, 6, v1
    v_lshlrev_b32 v14, 4, v14
    v_xor_b32 v15, 7, v1
    v_lshlrev_b32 v15, 4, v15
    v_xor_b32 v16, 8, v1
    v_lshlrev_b32 v16, 4, v16
    v_xor_b32 v17, 9, v1
    v_lshlrev_b32 v17, 4, v17
    v_xor_b32 v18, 10, v1
    v_lshlrev_b32 v18, 4, v18
    v_xor_b32 v19, 11, v1
    v_lshlrev_b32 v19, 4, v19
    v_xor_b32 v20, 12, v1
    v_lshlrev_b32 v20, 4, v20
    v_xor_b32 v21, 13, v1
    v_lshlrev_b32 v21, 4, v21
    v_xor_b32 v22, 14, v1
    v_lshlrev_b32 v22, 4, v22
    v_xor_b32 v23, 15, v1
    v_lshlrev_b32 v23, 4, v23
    s_lshl_b32 s30, s2, 17
    s_lshl_b32 s31, s3, 15
    s_add_u32 s30, s30, s31
    s_add_u32 s32, s31, 0
    s_mov_b32 m0, s32
    s_nop 0
    buffer_load_dwordx4 v8, s[12:15], s30 offen offset:0 nt lds
    buffer_load_dwordx4 v12, s[12:15], s30 offen offset:1024 nt lds
    buffer_load_dwordx4 v16, s[12:15], s30 offen offset:2048 nt lds
    buffer_load_dwordx4 v20, s[12:15], s30 offen offset:3072 nt lds
    s_add_u32 s32, s31, 4096
    s_mov_b32 m0, s32
    s_add_u32 s30, s30, 4096
    buffer_load_dwordx4 v9, s[12:15], s30 offen offset:0 nt lds
    buffer_load_dwordx4 v13, s[12:15], s30 offen offset:1024 nt lds
    buffer_load_dwordx4 v17, s[12:15], s30 offen offset:2048 nt lds
    buffer_load_dwordx4 v21, s[12:15], s30 offen offset:3072 nt lds
    s_add_u32 s32, s31, 8192
    s_mov_b32 m0, s32
    s_add_u32 s30, s30, 4096
    buffer_load_dwordx4 v10, s[12:15], s30 offen offset:0 nt lds
    buffer_load_dwordx4 v14, s[12:15], s30 offen offset:1024 nt lds
    buffer_load_dwordx4 v18, s[12:15], s30 offen offset:2048 nt lds
    buffer_load_dwordx4 v22, s[12:15], s30 offen offset:3072 nt lds
    s_add_u32 s32, s31, 12288
    s_mov_b32 m0, s32
    s_add_u32 s30, s30, 4096
    buffer_load_dwordx4 v11, s[12:15], s30 offen offset:0 nt lds
    buffer_load_dwordx4 v15, s[12:15], s30 offen offset:1024 nt lds
    buffer_load_dwordx4 v19, s[12:15], s30 offen offset:2048 nt lds
    buffer_load_dwordx4 v23, s[12:15], s30 offen offset:3072 nt lds
    s_add_u32 s32, s31, 16384
    s_mov_b32 m0, s32
    s_add_u32 s30, s30, 4096
    buffer_load_dwordx4 v8, s[12:15], s30 offen offset:0 nt lds
    buffer_load_dwordx4 v12, s[12:15], s30 offen offset:1024 nt lds
    buffer_load_dwordx4 v16, s[12:15], s30 offen offset:2048 nt lds
    buffer_load_dwordx4 v20, s[12:15], s30 offen offset:3072 nt lds
    s_add_u32 s32, s31, 20480
    s_mov_b32 m0, s32
    s_add_u32 s30, s30, 4096
    buffer_load_dwordx4 v9, s[12:15], s30 offen offset:0 nt lds
    buffer_load_dwordx4 v13, s[12:15], s30 offen offset:1024 nt lds
    buffer_load_dwordx4 v17, s[12:15], s30 offen offset:2048 nt lds
    buffer_load_dwordx4 v21, s[12:15], s30 offen offset:3072 nt lds
    s_add_u32 s32, s31, 24576
    s_mov_b32 m0, s32
    s_add_u32 s30, s30, 4096
    buffer_load_dwordx4 v10, s[12:15], s30 offen offset:0 nt lds
    buffer_load_dwordx4 v14, s[12:15], s30 offen offset:1024 nt lds
    buffer_load_dwordx4 v18, s[12:15], s30 offen offset:2048 nt lds
    buffer_load_dwordx4 v22, s[12:15], s30 offen offset:3072 nt lds
    s_add_u32 s32, s31, 28672
    s_mov_b32 m0, s32
    s_add_u32 s30, s30, 4096
    buffer_load_dwordx4 v11, s[12:15], s30 offen offset:0 nt lds
    buffer_load_dwordx4 v15, s[12:15], s30 offen offset:1024 nt lds
    buffer_load_dwordx4 v19, s[12:15], s30 offen offset:2048 nt lds
    buffer_load_dwordx4 v23, s[12:15], s30 offen offset:3072 nt lds
    v_and_b32 v4, 31, v1
    v_lshrrev_b32 v5, 5, v1
    v_and_b32 v6, 3, v4
    v_lshlrev_b32 v6, 2, v6
    v_bfe_u32 v7, v4, 2, 2
    v_or_b32 v6, v6, v7
    v_lshlrev_b32 v7, 10, v4
    v_add_u32 v7, s31, v7
    v_add_u32 v24, 0, v5
    v_xor_b32 v24, v24, v6
    v_lshl_add_u32 v24, v24, 4, v7
    v_add_u32 v25, 2, v5
    v_xor_b32 v25, v25, v6
    v_lshl_add_u32 v25, v25, 4, v7
    v_add_u32 v26, 4, v5
    v_xor_b32 v26, v26, v6
    v_lshl_add_u32 v26, v26, 4, v7
    v_add_u32 v27, 6, v5
    v_xor_b32 v27, v27, v6
    v_lshl_add_u32 v27, v27, 4, v7
    v_add_u32 v28, 8, v5
    v_xor_b32 v28, v28, v6
    v_lshl_add_u32 v28, v28, 4, v7
    v_add_u32 v29, 10, v5
    v_xor_b32 v29, v29, v6
    v_lshl_add_u32 v29, v29, 4, v7
    v_add_u32 v30, 12, v5
    v_xor_b32 v30, v30, v6
    v_lshl_add_u32 v30, v30, 4, v7
    v_add_u32 v31, 14, v5
    v_xor_b32 v31, v31, v6
    v_lshl_add_u32 v31, v31, 4, v7
    s_waitcnt vmcnt(32)
    v_lshlrev_b32 v64, 16, v128
    v_and_b32 v65, 0xffff0000, v128
    v_lshlrev_b32 v66, 16, v160
    v_and_b32 v67, 0xffff0000, v160
    v_add_f32 v64, v64, v66
    v_add_f32 v65, v65, v67
    v_cvt_pk_bf16_f32 v128, v64, v65
    v_lshlrev_b32 v68, 16, v129
    v_and_b32 v69, 0xffff0000, v129
    v_lshlrev_b32 v70, 16, v161
    v_and_b32 v71, 0xffff0000, v161
    v_add_f32 v68, v68, v70
    v_add_f32 v69, v69, v71
    v_cvt_pk_bf16_f32 v129, v68, v69
    v_lshlrev_b32 v72, 16, v130
    v_and_b32 v73, 0xffff0000, v130
    v_lshlrev_b32 v74, 16, v162
    v_and_b32 v75, 0xffff0000, v162
    v_add_f32 v72, v72, v74
    v_add_f32 v73, v73, v75
    v_cvt_pk_bf16_f32 v130, v72, v73
    v_lshlrev_b32 v76, 16, v131
    v_and_b32 v77, 0xffff0000, v131
    v_lshlrev_b32 v78, 16, v163
    v_and_b32 v79, 0xffff0000, v163
    v_add_f32 v76, v76, v78
    v_add_f32 v77, v77, v79
    v_cvt_pk_bf16_f32 v131, v76, v77
    v_lshlrev_b32 v64, 16, v132
    v_and_b32 v65, 0xffff0000, v132
    v_lshlrev_b32 v66, 16, v164
    v_and_b32 v67, 0xffff0000, v164
    v_add_f32 v64, v64, v66
    v_add_f32 v65, v65, v67
    v_cvt_pk_bf16_f32 v132, v64, v65
    v_lshlrev_b32 v68, 16, v133
    v_and_b32 v69, 0xffff0000, v133
    v_lshlrev_b32 v70, 16, v165
    v_and_b32 v71, 0xffff0000, v165
    v_add_f32 v68, v68, v70
    v_add_f32 v69, v69, v71
    v_cvt_pk_bf16_f32 v133, v68, v69
    v_lshlrev_b32 v72, 16, v134
    v_and_b32 v73, 0xffff0000, v134
    v_lshlrev_b32 v74, 16, v166
    v_and_b32 v75, 0xffff0000, v166
    v_add_f32 v72, v72, v74
    v_add_f32 v73, v73, v75
    v_cvt_pk_bf16_f32 v134, v72, v73
    v_lshlrev_b32 v76, 16, v135
    v_and_b32 v77, 0xffff0000, v135
    v_lshlrev_b32 v78, 16, v167
    v_and_b32 v79, 0xffff0000, v167
    v_add_f32 v76, v76, v78
    v_add_f32 v77, v77, v79
    v_cvt_pk_bf16_f32 v135, v76, v77
    v_lshlrev_b32 v64, 16, v136
    v_and_b32 v65, 0xffff0000, v136
    v_lshlrev_b32 v66, 16, v168
    v_and_b32 v67, 0xffff0000, v168
    v_add_f32 v64, v64, v66
    v_add_f32 v65, v65, v67
    v_cvt_pk_bf16_f32 v136, v64, v65
    v_lshlrev_b32 v68, 16, v137
    v_and_b32 v69, 0xffff0000, v137
    v_lshlrev_b32 v70, 16, v169
    v_and_b32 v71, 0xffff0000, v169
    v_add_f32 v68, v68, v70
    v_add_f32 v69, v69, v71
    v_cvt_pk_bf16_f32 v137, v68, v69
    v_lshlrev_b32 v72, 16, v138
    v_and_b32 v73, 0xffff0000, v138
    v_lshlrev_b32 v74, 16, v170
    v_and_b32 v75, 0xffff0000, v170
    v_add_f32 v72, v72, v74
    v_add_f32 v73, v73, v75
    v_cvt_pk_bf16_f32 v138, v72, v73
    v_lshlrev_b32 v76, 16, v139
    v_and_b32 v77, 0xffff0000, v139
    v_lshlrev_b32 v78, 16, v171
    v_and_b32 v79, 0xffff0000, v171
    v_add_f32 v76, v76, v78
    v_add_f32 v77, v77, v79
    v_cvt_pk_bf16_f32 v139, v76, v77
    v_lshlrev_b32 v64, 16, v140
    v_and_b32 v65, 0xffff0000, v140
    v_lshlrev_b32 v66, 16, v172
    v_and_b32 v67, 0xffff0000, v172
    v_add_f32 v64, v64, v66
    v_add_f32 v65, v65, v67
    v_cvt_pk_bf16_f32 v140, v64, v65
    v_lshlrev_b32 v68, 16, v141
    v_and_b32 v69, 0xffff0000, v141
    v_lshlrev_b32 v70, 16, v173
    v_and_b32 v71, 0xffff0000, v173
    v_add_f32 v68, v68, v70
    v_add_f32 v69, v69, v71
    v_cvt_pk_bf16_f32 v141, v68, v69
    v_lshlrev_b32 v72, 16, v142
    v_and_b32 v73, 0xffff0000, v142
    v_lshlrev_b32 v74, 16, v174
    v_and_b32 v75, 0xffff0000, v174
    v_add_f32 v72, v72, v74
    v_add_f32 v73, v73, v75
    v_cvt_pk_bf16_f32 v142, v72, v73
    v_lshlrev_b32 v76, 16, v143
    v_and_b32 v77, 0xffff0000, v143
    v_lshlrev_b32 v78, 16, v175
    v_and_b32 v79, 0xffff0000, v175
    v_add_f32 v76, v76, v78
    v_add_f32 v77, v77, v79
    v_cvt_pk_bf16_f32 v143, v76, v77
    v_lshlrev_b32 v64, 16, v144
    v_and_b32 v65, 0xffff0000, v144
    v_lshlrev_b32 v66, 16, v176
    v_and_b32 v67, 0xffff0000, v176
    v_add_f32 v64, v64, v66
    v_add_f32 v65, v65, v67
    v_cvt_pk_bf16_f32 v144, v64, v65
    v_lshlrev_b32 v68, 16, v145
    v_and_b32 v69, 0xffff0000, v145
    v_lshlrev_b32 v70, 16, v177
    v_and_b32 v71, 0xffff0000, v177
    v_add_f32 v68, v68, v70
    v_add_f32 v69, v69, v71
    v_cvt_pk_bf16_f32 v145, v68, v69
    v_lshlrev_b32 v72, 16, v146
    v_and_b32 v73, 0xffff0000, v146
    v_lshlrev_b32 v74, 16, v178
    v_and_b32 v75, 0xffff0000, v178
    v_add_f32 v72, v72, v74
    v_add_f32 v73, v73, v75
    v_cvt_pk_bf16_f32 v146, v72, v73
    v_lshlrev_b32 v76, 16, v147
    v_and_b32 v77, 0xffff0000, v147
    v_lshlrev_b32 v78, 16, v179
    v_and_b32 v79, 0xffff0000, v179
    v_add_f32 v76, v76, v78
    v_add_f32 v77, v77, v79
    v_cvt_pk_bf16_f32 v147, v76, v77
    v_lshlrev_b32 v64, 16, v148
    v_and_b32 v65, 0xffff0000, v148
    v_lshlrev_b32 v66, 16, v180
    v_and_b32 v67, 0xffff0000, v180
    v_add_f32 v64, v64, v66
    v_add_f32 v65, v65, v67
    v_cvt_pk_bf16_f32 v148, v64, v65
    v_lshlrev_b32 v68, 16, v149
    v_and_b32 v69, 0xffff0000, v149
    v_lshlrev_b32 v70, 16, v181
    v_and_b32 v71, 0xffff0000, v181
    v_add_f32 v68, v68, v70
    v_add_f32 v69, v69, v71
    v_cvt_pk_bf16_f32 v149, v68, v69
    v_lshlrev_b32 v72, 16, v150
    v_and_b32 v73, 0xffff0000, v150
    v_lshlrev_b32 v74, 16, v182
    v_and_b32 v75, 0xffff0000, v182
    v_add_f32 v72, v72, v74
    v_add_f32 v73, v73, v75
    v_cvt_pk_bf16_f32 v150, v72, v73
    v_lshlrev_b32 v76, 16, v151
    v_and_b32 v77, 0xffff0000, v151
    v_lshlrev_b32 v78, 16, v183
    v_and_b32 v79, 0xffff0000, v183
    v_add_f32 v76, v76, v78
    v_add_f32 v77, v77, v79
    v_cvt_pk_bf16_f32 v151, v76, v77
    v_lshlrev_b32 v64, 16, v152
    v_and_b32 v65, 0xffff0000, v152
    v_lshlrev_b32 v66, 16, v184
    v_and_b32 v67, 0xffff0000, v184
    v_add_f32 v64, v64, v66
    v_add_f32 v65, v65, v67
    v_cvt_pk_bf16_f32 v152, v64, v65
    v_lshlrev_b32 v68, 16, v153
    v_and_b32 v69, 0xffff0000, v153
    v_lshlrev_b32 v70, 16, v185
    v_and_b32 v71, 0xffff0000, v185
    v_add_f32 v68, v68, v70
    v_add_f32 v69, v69, v71
    v_cvt_pk_bf16_f32 v153, v68, v69
    v_lshlrev_b32 v72, 16, v154
    v_and_b32 v73, 0xffff0000, v154
    v_lshlrev_b32 v74, 16, v186
    v_and_b32 v75, 0xffff0000, v186
    v_add_f32 v72, v72, v74
    v_add_f32 v73, v73, v75
    v_cvt_pk_bf16_f32 v154, v72, v73
    v_lshlrev_b32 v76, 16, v155
    v_and_b32 v77, 0xffff0000, v155
    v_lshlrev_b32 v78, 16, v187
    v_and_b32 v79, 0xffff0000, v187
    v_add_f32 v76, v76, v78
    v_add_f32 v77, v77, v79
    v_cvt_pk_bf16_f32 v155, v76, v77
    v_lshlrev_b32 v64, 16, v156
    v_and_b32 v65, 0xffff0000, v156
    v_lshlrev_b32 v66, 16, v188
    v_and_b32 v67, 0xffff0000, v188
    v_add_f32 v64, v64, v66
    v_add_f32 v65, v65, v67
    v_cvt_pk_bf16_f32 v156, v64, v65
    v_lshlrev_b32 v68, 16, v157
    v_and_b32 v69, 0xffff0000, v157
    v_lshlrev_b32 v70, 16, v189
    v_and_b32 v71, 0xffff0000, v189
    v_add_f32 v68, v68, v70
    v_add_f32 v69, v69, v71
    v_cvt_pk_bf16_f32 v157, v68, v69
    v_lshlrev_b32 v72, 16, v158
    v_and_b32 v73, 0xffff0000, v158
    v_lshlrev_b32 v74, 16, v190
    v_and_b32 v75, 0xffff0000, v190
    v_add_f32 v72, v72, v74
    v_add_f32 v73, v73, v75
    v_cvt_pk_bf16_f32 v158, v72, v73
    v_lshlrev_b32 v76, 16, v159
    v_and_b32 v77, 0xffff0000, v159
    v_lshlrev_b32 v78, 16, v191
    v_and_b32 v79, 0xffff0000, v191
    v_add_f32 v76, v76, v78
    v_add_f32 v77, v77, v79
    v_cvt_pk_bf16_f32 v159, v76, v77
    v_add_u32 v33, 131072, v3
    s_lshl_b32 s34, s3, 13
    v_add_u32 v34, s34, v33
    ds_write_b128 v34, v[128:131] offset:0
    ds_write_b128 v34, v[132:135] offset:1024
    ds_write_b128 v34, v[136:139] offset:2048
    ds_write_b128 v34, v[140:143] offset:3072
    ds_write_b128 v34, v[144:147] offset:4096
    ds_write_b128 v34, v[148:151] offset:5120
    ds_write_b128 v34, v[152:155] offset:6144
    ds_write_b128 v34, v[156:159] offset:7168
    s_waitcnt lgkmcnt(0)
    s_barrier
    ds_read_b128 v[128:131], v33 offset:0
    ds_read_b128 v[132:135], v33 offset:1024
    ds_read_b128 v[136:139], v33 offset:2048
    ds_read_b128 v[140:143], v33 offset:3072
    ds_read_b128 v[144:147], v33 offset:4096
    ds_read_b128 v[148:151], v33 offset:5120
    ds_read_b128 v[152:155], v33 offset:6144
    ds_read_b128 v[156:159], v33 offset:7168
    ds_read_b128 v[160:163], v33 offset:8192
    ds_read_b128 v[164:167], v33 offset:9216
    ds_read_b128 v[168:171], v33 offset:10240
    ds_read_b128 v[172:175], v33 offset:11264
    ds_read_b128 v[176:179], v33 offset:12288
    ds_read_b128 v[180:183], v33 offset:13312
    ds_read_b128 v[184:187], v33 offset:14336
    ds_read_b128 v[188:191], v33 offset:15360
    ds_read_b128 v[192:195], v33 offset:16384
    ds_read_b128 v[196:199], v33 offset:17408
    ds_read_b128 v[200:203], v33 offset:18432
    ds_read_b128 v[204:207], v33 offset:19456
    ds_read_b128 v[208:211], v33 offset:20480
    ds_read_b128 v[212:215], v33 offset:21504
    ds_read_b128 v[216:219], v33 offset:22528
    ds_read_b128 v[220:223], v33 offset:23552
    ds_read_b128 v[224:227], v33 offset:24576
    ds_read_b128 v[228:231], v33 offset:25600
    ds_read_b128 v[232:235], v33 offset:26624
    ds_read_b128 v[236:239], v33 offset:27648
    ds_read_b128 v[240:243], v33 offset:28672
    ds_read_b128 v[244:247], v33 offset:29696
    ds_read_b128 v[248:251], v33 offset:30720
    ds_read_b128 v[252:255], v33 offset:31744
    s_waitcnt lgkmcnt(0)
    s_barrier
    s_waitcnt vmcnt(0)
    s_cmp_ge_u32 s3, 4
    s_cbranch_scc1 K2_PFA_701
    s_load_dwordx2 s[44:45], s[0:1], 32
    s_load_dwordx2 s[46:47], s[0:1], 40
    s_load_dwordx2 s[48:49], s[0:1], 56
    s_load_dwordx2 s[50:51], s[0:1], 64
    s_load_dwordx2 s[52:53], s[0:1], 72
    s_waitcnt lgkmcnt(0)
    s_mov_b32 s80, s44
    s_and_b32 s81, s45, 0xffff
    s_mov_b32 s82, 0x400000
    s_mov_b32 s83, 0x20000
    s_mov_b32 s84, s46
    s_and_b32 s85, s47, 0xffff
    s_mov_b32 s86, 0x480000
    s_mov_b32 s87, 0x20000
    s_mov_b32 s88, s48
    s_and_b32 s89, s49, 0xffff
    s_mov_b32 s90, 0x510000
    s_mov_b32 s91, 0x20000
    s_mov_b32 s92, s50
    s_and_b32 s93, s51, 0xffff
    s_mov_b32 s94, 0x510000
    s_mov_b32 s95, 0x20000
    s_mov_b32 s96, s52
    s_and_b32 s97, s53, 0xffff
    s_mov_b32 s98, 0x510000
    s_mov_b32 s99, 0x20000
    s_and_b32 s54, s2, 31
    s_lshr_b32 s55, s2, 5
    v_lshrrev_b32 v60, 1, v0
    v_and_b32 v61, 1, v0
    s_lshl_b32 s56, s55, 6
    v_add_u32 v62, s56, v60
    v_lshlrev_b32 v62, 13, v62
    v_lshl_add_u32 v62, v61, 7, v62
    s_lshl_b32 s56, s54, 8
    s_cmp_ge_u32 s3, 2
    s_cbranch_scc1 K2_PF_702
    buffer_load_dword a0, v62, s[80:83], s56 offen
K2_PF_702:
    s_movk_i32 s57, 1152
    v_mul_lo_u32 v62, v60, s57
    v_mul_u32_u24 v63, 140, v61
    v_add_u32 v62, v62, v63
    s_mul_i32 s56, s54, 147456
    s_mul_i32 s57, s55, 144
    s_add_u32 s56, s56, s57
    buffer_load_dword a1, v62, s[84:87], s56 offen
    v_lshrrev_b32 v60, 1, v0
    v_and_b32 v61, 1, v0
    s_movk_i32 s57, 1152
    v_mul_lo_u32 v62, v60, s57
    v_mul_u32_u24 v63, 140, v61
    v_add_u32 v62, v62, v63
    s_mul_i32 s56, s54, 165888
    s_mul_i32 s57, s55, 144
    s_add_u32 s56, s56, s57
    buffer_load_dword a2, v62, s[96:99], s56 offen
    s_cmp_lg_u32 s3, 0
    s_cbranch_scc1 K2_PFH_704
    s_add_u32 s56, s56, 147456
    s_mov_b64 exec, 0xffffffff
    buffer_load_dword a5, v62, s[96:99], s56 offen
    s_mov_b64 exec, -1
K2_PFH_704:
    s_cmp_ge_u32 s3, 3
    s_cbranch_scc1 K2_PFG_703
    s_cmp_ge_u32 s2, 216
    s_cbranch_scc1 K2_PFG_703
    s_mul_i32 s56, s2, 911
    s_lshr_b32 s56, s56, 16
    s_mul_i32 s57, s56, 72
    s_sub_u32 s57, s2, s57
    s_mul_i32 s56, s56, 192
    v_add_u32 v62, s56, v0
    s_movk_i32 s56, 9216
    v_mul_lo_u32 v62, v62, s56
    s_lshl_b32 s57, s57, 7
    buffer_load_dword a3, v62, s[88:91], s57 offen
    buffer_load_dword a4, v62, s[92:95], s57 offen
K2_PFG_703:
K2_PFA_701:
    ds_read_b128 v[64:67], v24 offset:0
    ds_read_b128 v[68:71], v25 offset:0
    ds_read_b128 v[72:75], v26 offset:0
    ds_read_b128 v[76:79], v27 offset:0
    ds_read_b128 v[80:83], v28 offset:0
    ds_read_b128 v[84:87], v29 offset:0
    ds_read_b128 v[88:91], v30 offset:0
    ds_read_b128 v[92:95], v31 offset:0
    ds_read_b128 v[96:99], v24 offset:256
    ds_read_b128 v[100:103], v25 offset:256
    ds_read_b128 v[104:107], v26 offset:256
    ds_read_b128 v[108:111], v27 offset:256
    ds_read_b128 v[112:115], v28 offset:256
    ds_read_b128 v[116:119], v29 offset:256
    ds_read_b128 v[120:123], v30 offset:256
    ds_read_b128 v[124:127], v31 offset:256
    s_waitcnt lgkmcnt(15)
    v_mfma_f32_32x32x16_bf16 v[32:47], v[64:67], v[128:131], 0
    s_waitcnt lgkmcnt(14)
    v_mfma_f32_32x32x16_bf16 v[32:47], v[68:71], v[132:135], v[32:47]
    s_waitcnt lgkmcnt(13)
    v_mfma_f32_32x32x16_bf16 v[32:47], v[72:75], v[136:139], v[32:47]
    s_waitcnt lgkmcnt(12)
    v_mfma_f32_32x32x16_bf16 v[32:47], v[76:79], v[140:143], v[32:47]
    s_waitcnt lgkmcnt(11)
    v_mfma_f32_32x32x16_bf16 v[32:47], v[80:83], v[144:147], v[32:47]
    s_waitcnt lgkmcnt(10)
    v_mfma_f32_32x32x16_bf16 v[32:47], v[84:87], v[148:151], v[32:47]
    s_waitcnt lgkmcnt(9)
    v_mfma_f32_32x32x16_bf16 v[32:47], v[88:91], v[152:155], v[32:47]
    s_waitcnt lgkmcnt(8)
    v_mfma_f32_32x32x16_bf16 v[32:47], v[92:95], v[156:159], v[32:47]
    s_waitcnt lgkmcnt(7)
    v_mfma_f32_32x32x16_bf16 v[32:47], v[96:99], v[160:163], v[32:47]
    s_waitcnt lgkmcnt(6)
    v_mfma_f32_32x32x16_bf16 v[32:47], v[100:103], v[164:167], v[32:47]
    s_waitcnt lgkmcnt(5)
    v_mfma_f32_32x32x16_bf16 v[32:47], v[104:107], v[168:171], v[32:47]
    s_waitcnt lgkmcnt(4)
    v_mfma_f32_32x32x16_bf16 v[32:47], v[108:111], v[172:175], v[32:47]
    s_waitcnt lgkmcnt(3)
    v_mfma_f32_32x32x16_bf16 v[32:47], v[112:115], v[176:179], v[32:47]
    s_waitcnt lgkmcnt(2)
    v_mfma_f32_32x32x16_bf16 v[32:47], v[116:119], v[180:183], v[32:47]
    s_waitcnt lgkmcnt(1)
    v_mfma_f32_32x32x16_bf16 v[32:47], v[120:123], v[184:187], v[32:47]
    s_waitcnt lgkmcnt(0)
    v_mfma_f32_32x32x16_bf16 v[32:47], v[124:127], v[188:191], v[32:47]
    ds_read_b128 v[64:67], v24 offset:512
    ds_read_b128 v[68:71], v25 offset:512
    ds_read_b128 v[72:75], v26 offset:512
    ds_read_b128 v[76:79], v27 offset:512
    ds_read_b128 v[80:83], v28 offset:512
    ds_read_b128 v[84:87], v29 offset:512
    ds_read_b128 v[88:91], v30 offset:512
    ds_read_b128 v[92:95], v31 offset:512
    ds_read_b128 v[96:99], v24 offset:768
    ds_read_b128 v[100:103], v25 offset:768
    ds_read_b128 v[104:107], v26 offset:768
    ds_read_b128 v[108:111], v27 offset:768
    ds_read_b128 v[112:115], v28 offset:768
    ds_read_b128 v[116:119], v29 offset:768
    ds_read_b128 v[120:123], v30 offset:768
    ds_read_b128 v[124:127], v31 offset:768
    s_waitcnt lgkmcnt(15)
    v_mfma_f32_32x32x16_bf16 v[32:47], v[64:67], v[192:195], v[32:47]
    s_waitcnt lgkmcnt(14)
    v_mfma_f32_32x32x16_bf16 v[32:47], v[68:71], v[196:199], v[32:47]
    s_waitcnt lgkmcnt(13)
    v_mfma_f32_32x32x16_bf16 v[32:47], v[72:75], v[200:203], v[32:47]
    s_waitcnt lgkmcnt(12)
    v_mfma_f32_32x32x16_bf16 v[32:47], v[76:79], v[204:207], v[32:47]
    s_waitcnt lgkmcnt(11)
    v_mfma_f32_32x32x16_bf16 v[32:47], v[80:83], v[208:211], v[32:47]
    s_waitcnt lgkmcnt(10)
    v_mfma_f32_32x32x16_bf16 v[32:47], v[84:87], v[212:215], v[32:47]
    s_waitcnt lgkmcnt(9)
    v_mfma_f32_32x32x16_bf16 v[32:47], v[88:91], v[216:219], v[32:47]
    s_waitcnt lgkmcnt(8)
    v_mfma_f32_32x32x16_bf16 v[32:47], v[92:95], v[220:223], v[32:47]
    s_waitcnt lgkmcnt(7)
    v_mfma_f32_32x32x16_bf16 v[32:47], v[96:99], v[224:227], v[32:47]
    s_waitcnt lgkmcnt(6)
    v_mfma_f32_32x32x16_bf16 v[32:47], v[100:103], v[228:231], v[32:47]
    s_waitcnt lgkmcnt(5)
    v_mfma_f32_32x32x16_bf16 v[32:47], v[104:107], v[232:235], v[32:47]
    s_waitcnt lgkmcnt(4)
    v_mfma_f32_32x32x16_bf16 v[32:47], v[108:111], v[236:239], v[32:47]
    s_waitcnt lgkmcnt(3)
    v_mfma_f32_32x32x16_bf16 v[32:47], v[112:115], v[240:243], v[32:47]
    s_waitcnt lgkmcnt(2)
    v_mfma_f32_32x32x16_bf16 v[32:47], v[116:119], v[244:247], v[32:47]
    s_waitcnt lgkmcnt(1)
    v_mfma_f32_32x32x16_bf16 v[32:47], v[120:123], v[248:251], v[32:47]
    s_waitcnt lgkmcnt(0)
    v_mfma_f32_32x32x16_bf16 v[32:47], v[124:127], v[252:255], v[32:47]
    s_nop 15
    v_max3_f32 v48, v32, v33, v34
    v_max3_f32 v48, v48, v35, v36
    v_max3_f32 v48, v48, v37, v38
    v_max3_f32 v48, v48, v39, v40
    v_max3_f32 v48, v48, v41, v42
    v_max3_f32 v48, v48, v43, v44
    v_max3_f32 v48, v48, v45, v46
    v_max_f32 v48, v48, v47
    v_mov_b32 v49, v48
    s_nop 1
    v_permlane32_swap_b32 v48, v49
    s_nop 1
    v_max_f32 v48, v48, v49
    s_lshl_b32 s32, s3, 7
    v_lshl_add_u32 v50, v4, 2, s32
    v_add_u32 v50, 0x20000, v50
    ds_write_b32 v50, v48 offset:8192
    s_waitcnt lgkmcnt(0)
    s_barrier
    v_lshlrev_b32 v51, 2, v4
    v_add_u32 v51, 0x20000, v51
    ds_read_b32 v52, v51 offset:8192
    ds_read_b32 v53, v51 offset:8320
    ds_read_b32 v54, v51 offset:8448
    ds_read_b32 v55, v51 offset:8576
    s_waitcnt lgkmcnt(0)
    v_max3_f32 v48, v52, v53, v54
    v_max_f32 v48, v48, v55
    v_sub_f32 v32, v32, v48
    v_sub_f32 v33, v33, v48
    v_sub_f32 v34, v34, v48
    v_sub_f32 v35, v35, v48
    v_sub_f32 v36, v36, v48
    v_sub_f32 v37, v37, v48
    v_sub_f32 v38, v38, v48
    v_sub_f32 v39, v39, v48
    v_sub_f32 v40, v40, v48
    v_sub_f32 v41, v41, v48
    v_sub_f32 v42, v42, v48
    v_sub_f32 v43, v43, v48
    v_sub_f32 v44, v44, v48
    v_sub_f32 v45, v45, v48
    v_sub_f32 v46, v46, v48
    v_sub_f32 v47, v47, v48
    v_exp_f32 v32, v32
    v_exp_f32 v33, v33
    v_exp_f32 v34, v34
    v_exp_f32 v35, v35
    v_exp_f32 v36, v36
    v_exp_f32 v37, v37
    v_exp_f32 v38, v38
    v_exp_f32 v39, v39
    v_exp_f32 v40, v40
    v_exp_f32 v41, v41
    v_exp_f32 v42, v42
    v_exp_f32 v43, v43
    v_exp_f32 v44, v44
    v_exp_f32 v45, v45
    v_exp_f32 v46, v46
    v_exp_f32 v47, v47
    s_nop 0
    v_add_f32 v49, v32, v33
    v_add_f32 v49, v49, v34
    v_add_f32 v49, v49, v35
    v_add_f32 v49, v49, v36
    v_add_f32 v49, v49, v37
    v_add_f32 v49, v49, v38
    v_add_f32 v49, v49, v39
    v_add_f32 v49, v49, v40
    v_add_f32 v49, v49, v41
    v_add_f32 v49, v49, v42
    v_add_f32 v49, v49, v43
    v_add_f32 v49, v49, v44
    v_add_f32 v49, v49, v45
    v_add_f32 v49, v49, v46
    v_add_f32 v49, v49, v47
    v_cvt_pk_bf16_f32 v56, v32, v33
    v_cvt_pk_bf16_f32 v57, v34, v35
    v_cvt_pk_bf16_f32 v58, v36, v37
    v_cvt_pk_bf16_f32 v59, v38, v39
    v_cvt_pk_bf16_f32 v60, v40, v41
    v_cvt_pk_bf16_f32 v61, v42, v43
    v_cvt_pk_bf16_f32 v62, v44, v45
    v_cvt_pk_bf16_f32 v63, v46, v47
    v_mov_b32 v52, v49
    s_nop 1
    v_permlane32_swap_b32 v49, v52
    s_nop 1
    v_add_f32 v49, v49, v52
    ds_write_b32 v50, v49 offset:8704
    s_lshl_b32 s32, s3, 11
    v_lshl_add_u32 v53, v1, 4, s32
    v_add_u32 v53, 0x20000, v53
    ds_write_b128 v53, v[56:59] offset:0
    ds_write_b128 v53, v[60:63] offset:1024
    s_waitcnt lgkmcnt(0)
    s_barrier
    v_lshlrev_b32 v53, 4, v1
    v_add_u32 v53, 0x20000, v53
    ds_read_b128 v[128:131], v53 offset:0
    ds_read_b128 v[132:135], v53 offset:1024
    ds_read_b128 v[136:139], v53 offset:2048
    ds_read_b128 v[140:143], v53 offset:3072
    ds_read_b128 v[144:147], v53 offset:4096
    ds_read_b128 v[148:151], v53 offset:5120
    ds_read_b128 v[152:155], v53 offset:6144
    ds_read_b128 v[156:159], v53 offset:7168
    ds_read_b32 v52, v51 offset:8704
    ds_read_b32 v53, v51 offset:8832
    ds_read_b32 v54, v51 offset:8960
    ds_read_b32 v55, v51 offset:9088
    v_and_b32 v6, 15, v1
    v_lshrrev_b32 v7, 2, v6
    v_and_b32 v8, 3, v6
    v_bfe_u32 v9, v1, 4, 1
    v_lshlrev_b32 v10, 2, v5
    v_add_u32 v10, v10, v7
    v_lshlrev_b32 v10, 10, v10
    s_lshl_b32 s32, s3, 8
    v_add_u32 v10, s32, v10
    v_and_b32 v11, 1, v8
    v_lshl_add_u32 v10, v11, 3, v10
    v_lshrrev_b32 v11, 1, v8
    v_lshl_add_u32 v11, v9, 1, v11
    v_lshlrev_b32 v12, 2, v7
    v_add_u32 v12, v12, v5
    v_add_u32 v24, 0, v11
    v_add_u32 v13, 0, v12
    v_xor_b32 v24, v24, v13
    v_lshl_add_u32 v24, v24, 4, v10
    v_add_u32 v25, 0, v11
    v_add_u32 v13, 2, v12
    v_xor_b32 v25, v25, v13
    v_lshl_add_u32 v25, v25, 4, v10
    v_add_u32 v25, 8192, v25
    v_add_u32 v26, 4, v11
    v_add_u32 v13, 0, v12
    v_xor_b32 v26, v26, v13
    v_lshl_add_u32 v26, v26, 4, v10
    v_add_u32 v27, 4, v11
    v_add_u32 v13, 2, v12
    v_xor_b32 v27, v27, v13
    v_lshl_add_u32 v27, v27, 4, v10
    v_add_u32 v27, 8192, v27
    v_add_u32 v28, 8, v11
    v_add_u32 v13, 0, v12
    v_xor_b32 v28, v28, v13
    v_lshl_add_u32 v28, v28, 4, v10
    v_add_u32 v29, 8, v11
    v_add_u32 v13, 2, v12
    v_xor_b32 v29, v29, v13
    v_lshl_add_u32 v29, v29, 4, v10
    v_add_u32 v29, 8192, v29
    v_add_u32 v30, 12, v11
    v_add_u32 v13, 0, v12
    v_xor_b32 v30, v30, v13
    v_lshl_add_u32 v30, v30, 4, v10
    v_add_u32 v31, 12, v11
    v_add_u32 v13, 2, v12
    v_xor_b32 v31, v31, v13
    v_lshl_add_u32 v31, v31, 4, v10
    v_add_u32 v31, 8192, v31
    v_add_u32 v16, 0x10000, v24
    v_add_u32 v17, 0x10000, v25
    v_add_u32 v18, 0x10000, v26
    v_add_u32 v19, 0x10000, v27
    v_add_u32 v20, 0x10000, v28
    v_add_u32 v21, 0x10000, v29
    v_add_u32 v22, 0x10000, v30
    v_add_u32 v23, 0x10000, v31
    s_waitcnt lgkmcnt(0)
    v_add_f32 v52, v52, v53
    v_add_f32 v54, v54, v55
    v_add_f32 v49, v52, v54
    ds_read_b64_tr_b16 v[64:65], v24 offset:0
    ds_read_b64_tr_b16 v[66:67], v25 offset:0
    ds_read_b64_tr_b16 v[68:69], v26 offset:0
    ds_read_b64_tr_b16 v[70:71], v27 offset:0
    ds_read_b64_tr_b16 v[72:73], v28 offset:0
    ds_read_b64_tr_b16 v[74:75], v29 offset:0
    ds_read_b64_tr_b16 v[76:77], v30 offset:0
    ds_read_b64_tr_b16 v[78:79], v31 offset:0
    ds_read_b64_tr_b16 v[80:81], v24 offset:16384
    ds_read_b64_tr_b16 v[82:83], v25 offset:16384
    ds_read_b64_tr_b16 v[84:85], v26 offset:16384
    ds_read_b64_tr_b16 v[86:87], v27 offset:16384
    ds_read_b64_tr_b16 v[88:89], v28 offset:16384
    ds_read_b64_tr_b16 v[90:91], v29 offset:16384
    ds_read_b64_tr_b16 v[92:93], v30 offset:16384
    ds_read_b64_tr_b16 v[94:95], v31 offset:16384
    s_waitcnt lgkmcnt(14)
    v_mfma_f32_32x32x16_bf16 v[160:175], v[64:67], v[128:131], 0
    s_waitcnt lgkmcnt(12)
    v_mfma_f32_32x32x16_bf16 v[176:191], v[68:71], v[128:131], 0
    s_waitcnt lgkmcnt(10)
    v_mfma_f32_32x32x16_bf16 v[192:207], v[72:75], v[128:131], 0
    s_waitcnt lgkmcnt(8)
    v_mfma_f32_32x32x16_bf16 v[208:223], v[76:79], v[128:131], 0
    ds_read_b64_tr_b16 v[64:65], v24 offset:32768
    ds_read_b64_tr_b16 v[66:67], v25 offset:32768
    ds_read_b64_tr_b16 v[68:69], v26 offset:32768
    ds_read_b64_tr_b16 v[70:71], v27 offset:32768
    ds_read_b64_tr_b16 v[72:73], v28 offset:32768
    ds_read_b64_tr_b16 v[74:75], v29 offset:32768
    ds_read_b64_tr_b16 v[76:77], v30 offset:32768
    ds_read_b64_tr_b16 v[78:79], v31 offset:32768
    s_waitcnt lgkmcnt(14)
    v_mfma_f32_32x32x16_bf16 v[160:175], v[80:83], v[132:135], v[160:175]
    s_waitcnt lgkmcnt(12)
    v_mfma_f32_32x32x16_bf16 v[176:191], v[84:87], v[132:135], v[176:191]
    s_waitcnt lgkmcnt(10)
    v_mfma_f32_32x32x16_bf16 v[192:207], v[88:91], v[132:135], v[192:207]
    s_waitcnt lgkmcnt(8)
    v_mfma_f32_32x32x16_bf16 v[208:223], v[92:95], v[132:135], v[208:223]
    ds_read_b64_tr_b16 v[80:81], v24 offset:49152
    ds_read_b64_tr_b16 v[82:83], v25 offset:49152
    ds_read_b64_tr_b16 v[84:85], v26 offset:49152
    ds_read_b64_tr_b16 v[86:87], v27 offset:49152
    ds_read_b64_tr_b16 v[88:89], v28 offset:49152
    ds_read_b64_tr_b16 v[90:91], v29 offset:49152
    ds_read_b64_tr_b16 v[92:93], v30 offset:49152
    ds_read_b64_tr_b16 v[94:95], v31 offset:49152
    s_waitcnt lgkmcnt(14)
    v_mfma_f32_32x32x16_bf16 v[160:175], v[64:67], v[136:139], v[160:175]
    s_waitcnt lgkmcnt(12)
    v_mfma_f32_32x32x16_bf16 v[176:191], v[68:71], v[136:139], v[176:191]
    s_waitcnt lgkmcnt(10)
    v_mfma_f32_32x32x16_bf16 v[192:207], v[72:75], v[136:139], v[192:207]
    s_waitcnt lgkmcnt(8)
    v_mfma_f32_32x32x16_bf16 v[208:223], v[76:79], v[136:139], v[208:223]
    ds_read_b64_tr_b16 v[64:65], v16 offset:0
    ds_read_b64_tr_b16 v[66:67], v17 offset:0
    ds_read_b64_tr_b16 v[68:69], v18 offset:0
    ds_read_b64_tr_b16 v[70:71], v19 offset:0
    ds_read_b64_tr_b16 v[72:73], v20 offset:0
    ds_read_b64_tr_b16 v[74:75], v21 offset:0
    ds_read_b64_tr_b16 v[76:77], v22 offset:0
    ds_read_b64_tr_b16 v[78:79], v23 offset:0
    s_waitcnt lgkmcnt(14)
    v_mfma_f32_32x32x16_bf16 v[160:175], v[80:83], v[140:143], v[160:175]
    s_waitcnt lgkmcnt(12)
    v_mfma_f32_32x32x16_bf16 v[176:191], v[84:87], v[140:143], v[176:191]
    s_waitcnt lgkmcnt(10)
    v_mfma_f32_32x32x16_bf16 v[192:207], v[88:91], v[140:143], v[192:207]
    s_waitcnt lgkmcnt(8)
    v_mfma_f32_32x32x16_bf16 v[208:223], v[92:95], v[140:143], v[208:223]
    ds_read_b64_tr_b16 v[80:81], v16 offset:16384
    ds_read_b64_tr_b16 v[82:83], v17 offset:16384
    ds_read_b64_tr_b16 v[84:85], v18 offset:16384
    ds_read_b64_tr_b16 v[86:87], v19 offset:16384
    ds_read_b64_tr_b16 v[88:89], v20 offset:16384
    ds_read_b64_tr_b16 v[90:91], v21 offset:16384
    ds_read_b64_tr_b16 v[92:93], v22 offset:16384
    ds_read_b64_tr_b16 v[94:95], v23 offset:16384
    s_waitcnt lgkmcnt(14)
    v_mfma_f32_32x32x16_bf16 v[160:175], v[64:67], v[144:147], v[160:175]
    s_waitcnt lgkmcnt(12)
    v_mfma_f32_32x32x16_bf16 v[176:191], v[68:71], v[144:147], v[176:191]
    s_waitcnt lgkmcnt(10)
    v_mfma_f32_32x32x16_bf16 v[192:207], v[72:75], v[144:147], v[192:207]
    s_waitcnt lgkmcnt(8)
    v_mfma_f32_32x32x16_bf16 v[208:223], v[76:79], v[144:147], v[208:223]
    ds_read_b64_tr_b16 v[64:65], v16 offset:32768
    ds_read_b64_tr_b16 v[66:67], v17 offset:32768
    ds_read_b64_tr_b16 v[68:69], v18 offset:32768
    ds_read_b64_tr_b16 v[70:71], v19 offset:32768
    ds_read_b64_tr_b16 v[72:73], v20 offset:32768
    ds_read_b64_tr_b16 v[74:75], v21 offset:32768
    ds_read_b64_tr_b16 v[76:77], v22 offset:32768
    ds_read_b64_tr_b16 v[78:79], v23 offset:32768
    s_waitcnt lgkmcnt(14)
    v_mfma_f32_32x32x16_bf16 v[160:175], v[80:83], v[148:151], v[160:175]
    s_waitcnt lgkmcnt(12)
    v_mfma_f32_32x32x16_bf16 v[176:191], v[84:87], v[148:151], v[176:191]
    s_waitcnt lgkmcnt(10)
    v_mfma_f32_32x32x16_bf16 v[192:207], v[88:91], v[148:151], v[192:207]
    s_waitcnt lgkmcnt(8)
    v_mfma_f32_32x32x16_bf16 v[208:223], v[92:95], v[148:151], v[208:223]
    ds_read_b64_tr_b16 v[80:81], v16 offset:49152
    ds_read_b64_tr_b16 v[82:83], v17 offset:49152
    ds_read_b64_tr_b16 v[84:85], v18 offset:49152
    ds_read_b64_tr_b16 v[86:87], v19 offset:49152
    ds_read_b64_tr_b16 v[88:89], v20 offset:49152
    ds_read_b64_tr_b16 v[90:91], v21 offset:49152
    ds_read_b64_tr_b16 v[92:93], v22 offset:49152
    ds_read_b64_tr_b16 v[94:95], v23 offset:49152
    s_waitcnt lgkmcnt(14)
    v_mfma_f32_32x32x16_bf16 v[160:175], v[64:67], v[152:155], v[160:175]
    s_waitcnt lgkmcnt(12)
    v_mfma_f32_32x32x16_bf16 v[176:191], v[68:71], v[152:155], v[176:191]
    s_waitcnt lgkmcnt(10)
    v_mfma_f32_32x32x16_bf16 v[192:207], v[72:75], v[152:155], v[192:207]
    s_waitcnt lgkmcnt(8)
    v_mfma_f32_32x32x16_bf16 v[208:223], v[76:79], v[152:155], v[208:223]
    s_waitcnt lgkmcnt(6)
    v_mfma_f32_32x32x16_bf16 v[160:175], v[80:83], v[156:159], v[160:175]
    s_waitcnt lgkmcnt(4)
    v_mfma_f32_32x32x16_bf16 v[176:191], v[84:87], v[156:159], v[176:191]
    s_waitcnt lgkmcnt(2)
    v_mfma_f32_32x32x16_bf16 v[192:207], v[88:91], v[156:159], v[192:207]
    s_waitcnt lgkmcnt(0)
    v_mfma_f32_32x32x16_bf16 v[208:223], v[92:95], v[156:159], v[208:223]
    s_cmp_lg_u32 s3, 0
    s_cbranch_scc1 K2_NS_1
    s_lshl_b32 s32, s28, 5
    v_add_u32 v6, s32, v4
    v_lshlrev_b32 v6, 10, v6
    s_lshl_b32 s32, s29, 3
    s_add_u32 s32, s32, 0x20000
    v_add_u32 v6, s32, v6
    v_cmp_gt_u32 vcc, 32, v1
    s_and_saveexec_b64 s[42:43], vcc
    buffer_store_dwordx2 v[48:49], v6, s[24:27], 0 offen
    s_mov_b64 exec, s[42:43]
K2_NS_1:
    v_lshlrev_b32 v6, 10, v4
    s_lshl_b32 s32, s3, 8
    v_add_u32 v6, s32, v6
    v_lshl_add_u32 v6, v5, 3, v6
    v_and_b32 v7, 15, v4
    s_nop 7
    v_cvt_pk_bf16_f32 v64, v160, v161
    v_cvt_pk_bf16_f32 v65, v162, v163
    v_xor_b32 v8, 0, v7
    v_lshl_add_u32 v8, v8, 4, v6
    ds_write_b64 v8, v[64:65]
    v_cvt_pk_bf16_f32 v66, v164, v165
    v_cvt_pk_bf16_f32 v67, v166, v167
    v_xor_b32 v8, 1, v7
    v_lshl_add_u32 v8, v8, 4, v6
    ds_write_b64 v8, v[66:67]
    v_cvt_pk_bf16_f32 v68, v168, v169
    v_cvt_pk_bf16_f32 v69, v170, v171
    v_xor_b32 v8, 2, v7
    v_lshl_add_u32 v8, v8, 4, v6
    ds_write_b64 v8, v[68:69]
    v_cvt_pk_bf16_f32 v70, v172, v173
    v_cvt_pk_bf16_f32 v71, v174, v175
    v_xor_b32 v8, 3, v7
    v_lshl_add_u32 v8, v8, 4, v6
    ds_write_b64 v8, v[70:71]
    v_cvt_pk_bf16_f32 v72, v176, v177
    v_cvt_pk_bf16_f32 v73, v178, v179
    v_xor_b32 v8, 4, v7
    v_lshl_add_u32 v8, v8, 4, v6
    ds_write_b64 v8, v[72:73]
    v_cvt_pk_bf16_f32 v74, v180, v181
    v_cvt_pk_bf16_f32 v75, v182, v183
    v_xor_b32 v8, 5, v7
    v_lshl_add_u32 v8, v8, 4, v6
    ds_write_b64 v8, v[74:75]
    v_cvt_pk_bf16_f32 v76, v184, v185
    v_cvt_pk_bf16_f32 v77, v186, v187
    v_xor_b32 v8, 6, v7
    v_lshl_add_u32 v8, v8, 4, v6
    ds_write_b64 v8, v[76:77]
    v_cvt_pk_bf16_f32 v78, v188, v189
    v_cvt_pk_bf16_f32 v79, v190, v191
    v_xor_b32 v8, 7, v7
    v_lshl_add_u32 v8, v8, 4, v6
    ds_write_b64 v8, v[78:79]
    v_cvt_pk_bf16_f32 v64, v192, v193
    v_cvt_pk_bf16_f32 v65, v194, v195
    v_xor_b32 v8, 8, v7
    v_lshl_add_u32 v8, v8, 4, v6
    ds_write_b64 v8, v[64:65]
    v_cvt_pk_bf16_f32 v66, v196, v197
    v_cvt_pk_bf16_f32 v67, v198, v199
    v_xor_b32 v8, 9, v7
    v_lshl_add_u32 v8, v8, 4, v6
    ds_write_b64 v8, v[66:67]
    v_cvt_pk_bf16_f32 v68, v200, v201
    v_cvt_pk_bf16_f32 v69, v202, v203
    v_xor_b32 v8, 10, v7
    v_lshl_add_u32 v8, v8, 4, v6
    ds_write_b64 v8, v[68:69]
    v_cvt_pk_bf16_f32 v70, v204, v205
    v_cvt_pk_bf16_f32 v71, v206, v207
    v_xor_b32 v8, 11, v7
    v_lshl_add_u32 v8, v8, 4, v6
    ds_write_b64 v8, v[70:71]
    v_cvt_pk_bf16_f32 v72, v208, v209
    v_cvt_pk_bf16_f32 v73, v210, v211
    v_xor_b32 v8, 12, v7
    v_lshl_add_u32 v8, v8, 4, v6
    ds_write_b64 v8, v[72:73]
    v_cvt_pk_bf16_f32 v74, v212, v213
    v_cvt_pk_bf16_f32 v75, v214, v215
    v_xor_b32 v8, 13, v7
    v_lshl_add_u32 v8, v8, 4, v6
    ds_write_b64 v8, v[74:75]
    v_cvt_pk_bf16_f32 v76, v216, v217
    v_cvt_pk_bf16_f32 v77, v218, v219
    v_xor_b32 v8, 14, v7
    v_lshl_add_u32 v8, v8, 4, v6
    ds_write_b64 v8, v[76:77]
    v_cvt_pk_bf16_f32 v78, v220, v221
    v_cvt_pk_bf16_f32 v79, v222, v223
    v_xor_b32 v8, 15, v7
    v_lshl_add_u32 v8, v8, 4, v6
    ds_write_b64 v8, v[78:79]
    v_lshrrev_b32 v6, 4, v1
    v_and_b32 v7, 15, v1
    s_lshl_b32 s33, s28, 5
    v_add_u32 v9, s33, v6
    v_lshlrev_b32 v9, 17, v9
    v_lshrrev_b32 v10, 3, v7
    v_lshl_add_u32 v9, v10, 14, v9
    v_and_b32 v10, 7, v7
    v_lshl_add_u32 v9, v10, 4, v9
    s_lshl_b32 s33, s3, 15
    s_lshl_b32 s34, s29, 7
    s_add_u32 s33, s33, s34
    s_add_u32 s33, s33, 0x400000
    s_waitcnt lgkmcnt(0)
    v_add_u32 v10, 0, v6
    v_and_b32 v11, 15, v10
    v_xor_b32 v11, v11, v7
    v_lshlrev_b32 v10, 10, v10
    v_lshl_add_u32 v10, v11, 4, v10
    v_add_u32 v10, s32, v10
    ds_read_b128 v[96:99], v10
    v_add_u32 v10, 4, v6
    v_and_b32 v11, 15, v10
    v_xor_b32 v11, v11, v7
    v_lshlrev_b32 v10, 10, v10
    v_lshl_add_u32 v10, v11, 4, v10
    v_add_u32 v10, s32, v10
    ds_read_b128 v[100:103], v10
    v_add_u32 v10, 8, v6
    v_and_b32 v11, 15, v10
    v_xor_b32 v11, v11, v7
    v_lshlrev_b32 v10, 10, v10
    v_lshl_add_u32 v10, v11, 4, v10
    v_add_u32 v10, s32, v10
    ds_read_b128 v[104:107], v10
    v_add_u32 v10, 12, v6
    v_and_b32 v11, 15, v10
    v_xor_b32 v11, v11, v7
    v_lshlrev_b32 v10, 10, v10
    v_lshl_add_u32 v10, v11, 4, v10
    v_add_u32 v10, s32, v10
    ds_read_b128 v[108:111], v10
    v_add_u32 v10, 16, v6
    v_and_b32 v11, 15, v10
    v_xor_b32 v11, v11, v7
    v_lshlrev_b32 v10, 10, v10
    v_lshl_add_u32 v10, v11, 4, v10
    v_add_u32 v10, s32, v10
    ds_read_b128 v[112:115], v10
    v_add_u32 v10, 20, v6
    v_and_b32 v11, 15, v10
    v_xor_b32 v11, v11, v7
    v_lshlrev_b32 v10, 10, v10
    v_lshl_add_u32 v10, v11, 4, v10
    v_add_u32 v10, s32, v10
    ds_read_b128 v[116:119], v10
    v_add_u32 v10, 24, v6
    v_and_b32 v11, 15, v10
    v_xor_b32 v11, v11, v7
    v_lshlrev_b32 v10, 10, v10
    v_lshl_add_u32 v10, v11, 4, v10
    v_add_u32 v10, s32, v10
    ds_read_b128 v[120:123], v10
    v_add_u32 v10, 28, v6
    v_and_b32 v11, 15, v10
    v_xor_b32 v11, v11, v7
    v_lshlrev_b32 v10, 10, v10
    v_lshl_add_u32 v10, v11, 4, v10
    v_add_u32 v10, s32, v10
    ds_read_b128 v[124:127], v10
    s_waitcnt lgkmcnt(7)
    buffer_store_dwordx4 v[96:99], v9, s[24:27], s33 offen
    s_add_u32 s33, s33, 524288
    s_waitcnt lgkmcnt(6)
    buffer_store_dwordx4 v[100:103], v9, s[24:27], s33 offen
    s_add_u32 s33, s33, 524288
    s_waitcnt lgkmcnt(5)
    buffer_store_dwordx4 v[104:107], v9, s[24:27], s33 offen
    s_add_u32 s33, s33, 524288
    s_waitcnt lgkmcnt(4)
    buffer_store_dwordx4 v[108:111], v9, s[24:27], s33 offen
    s_add_u32 s33, s33, 524288
    s_waitcnt lgkmcnt(3)
    buffer_store_dwordx4 v[112:115], v9, s[24:27], s33 offen
    s_add_u32 s33, s33, 524288
    s_waitcnt lgkmcnt(2)
    buffer_store_dwordx4 v[116:119], v9, s[24:27], s33 offen
    s_add_u32 s33, s33, 524288
    s_waitcnt lgkmcnt(1)
    buffer_store_dwordx4 v[120:123], v9, s[24:27], s33 offen
    s_add_u32 s33, s33, 524288
    s_waitcnt lgkmcnt(0)
    buffer_store_dwordx4 v[124:127], v9, s[24:27], s33 offen
K2_END:
    s_endpgm
.globl t_kernel
.p2align 8
.type t_kernel,@function
t_kernel:
    s_cmp_ge_u32 s2, 256
    s_cbranch_scc1 T_END
    s_load_dwordx2 s[4:5], s[0:1], 0
    s_load_dwordx2 s[6:7], s[0:1], 56
    s_load_dwordx2 s[8:9], s[0:1], 64
    s_load_dwordx2 s[34:35], s[0:1], 72
    s_load_dwordx2 s[54:55], s[0:1], 32
    s_load_dwordx2 s[56:57], s[0:1], 40
    s_load_dwordx2 s[10:11], s[0:1], 96
    v_and_b32 v1, 63, v0
    v_lshrrev_b32 v2, 6, v0
    s_nop 0
    v_readfirstlane_b32 s3, v2
    s_waitcnt lgkmcnt(0)
    s_mov_b32 s12, s4
    s_and_b32 s13, s5, 0xffff
    s_mov_b32 s14, 0x900
    s_mov_b32 s15, 0x20000
    s_mov_b32 s16, s6
    s_and_b32 s17, s7, 0xffff
    s_mov_b32 s18, 0x510000
    s_mov_b32 s19, 0x20000
    s_mov_b32 s20, s8
    s_and_b32 s21, s9, 0xffff
    s_mov_b32 s22, 0x510000
    s_mov_b32 s23, 0x20000
    s_mov_b32 s36, s34
    s_and_b32 s37, s35, 0xffff
    s_mov_b32 s38, 0x510000
    s_mov_b32 s39, 0x20000
    s_mov_b32 s64, s54
    s_and_b32 s65, s55, 0xffff
    s_mov_b32 s66, 0x400000
    s_mov_b32 s67, 0x20000
    s_mov_b32 s68, s56
    s_and_b32 s69, s57, 0xffff
    s_mov_b32 s70, 0x480000
    s_mov_b32 s71, 0x20000
    s_mov_b32 s24, s10
    s_and_b32 s25, s11, 0xffff
    s_mov_b32 s26, 0x1000000
    s_mov_b32 s27, 0x20000
    s_and_b32 s28, s2, 31
    s_lshr_b32 s29, s2, 5
    v_cmp_gt_u32 s[44:45], 32, v1
    s_sub_u32 s51, s3, 4
    s_cmp_gt_u32 s51, 1
    s_cbranch_scc1 T_NS_1
    s_lshl_b32 s30, s51, 5
    s_add_u32 s30, s30, s28
    s_lshl_b32 s30, s30, 10
    s_add_u32 s30, s30, 0x20000
    v_lshlrev_b32 v3, 3, v1
    buffer_load_dwordx2 v[8:9], v3, s[24:27], s30 offen
    buffer_load_dwordx2 v[10:11], v3, s[24:27], s30 offen offset:512
T_NS_1:
    v_lshrrev_b32 v4, 3, v1
    v_and_b32 v5, 7, v1
    v_add_u32 v6, 0, v4
    v_bfe_u32 v16, v6, 1, 1
    v_bfe_u32 v6, v6, 3, 1
    v_lshl_or_b32 v16, v6, 1, v16
    v_lshlrev_b32 v16, 1, v16
    v_xor_b32 v16, v16, v5
    v_lshlrev_b32 v16, 4, v16
    s_mov_b32 s50, 128
    v_mul_lo_u32 v6, v4, s50
    v_add_u32 v16, v16, v6
    v_add_u32 v6, 8, v4
    v_bfe_u32 v17, v6, 1, 1
    v_bfe_u32 v6, v6, 3, 1
    v_lshl_or_b32 v17, v6, 1, v17
    v_lshlrev_b32 v17, 1, v17
    v_xor_b32 v17, v17, v5
    v_lshlrev_b32 v17, 4, v17
    s_mov_b32 s50, 128
    v_mul_lo_u32 v6, v4, s50
    v_add_u32 v17, v17, v6
    s_lshr_b32 s31, s3, 2
    s_lshl_b32 s31, s31, 5
    s_add_u32 s31, s31, s28
    s_lshl_b32 s31, s31, 3
    s_add_u32 s31, s31, s29
    s_lshl_b32 s31, s31, 14
    s_and_b32 s32, s3, 3
    s_lshl_b32 s32, s32, 12
    s_add_u32 s31, s31, s32
    s_add_u32 s31, s31, 0x400000
    s_lshl_b32 s33, s3, 12
    s_mov_b32 m0, s33
    s_nop 0
    buffer_load_dwordx4 v16, s[24:27], s31 offen offset:0 lds
    buffer_load_dwordx4 v17, s[24:27], s31 offen offset:1024 lds
    buffer_load_dwordx4 v16, s[24:27], s31 offen offset:2048 lds
    buffer_load_dwordx4 v17, s[24:27], s31 offen offset:3072 lds
    v_lshrrev_b32 v4, 4, v1
    v_and_b32 v5, 15, v1
    v_add_u32 v6, 0, v4
    v_and_b32 v18, 3, v6
    v_bfe_u32 v6, v6, 3, 1
    v_lshl_or_b32 v18, v6, 2, v18
    v_lshlrev_b32 v18, 1, v18
    v_xor_b32 v18, v18, v5
    v_lshlrev_b32 v18, 4, v18
    s_mov_b32 s50, 8192
    v_mul_lo_u32 v6, v4, s50
    v_add_u32 v18, v18, v6
    v_add_u32 v6, 8, v4
    v_and_b32 v19, 3, v6
    v_bfe_u32 v6, v6, 3, 1
    v_lshl_or_b32 v19, v6, 2, v19
    v_lshlrev_b32 v19, 1, v19
    v_xor_b32 v19, v19, v5
    v_lshlrev_b32 v19, 4, v19
    s_mov_b32 s50, 8192
    v_mul_lo_u32 v6, v4, s50
    v_add_u32 v19, v19, v6
    s_lshl_b32 s31, s29, 6
    s_lshl_b32 s32, s3, 3
    s_add_u32 s31, s31, s32
    s_lshl_b32 s31, s31, 13
    s_lshl_b32 s32, s28, 8
    s_add_u32 s31, s31, s32
    s_lshl_b32 s33, s3, 11
    s_add_u32 s33, s33, 32768
    s_bitcmp1_b32 s3, 0
    s_cselect_b64 s[46:47], -1, 0
    v_cndmask_b32 v20, v18, v19, s[46:47]
    s_mov_b32 m0, s33
    s_nop 0
    buffer_load_dwordx4 v20, s[64:67], s31 offen lds
    s_add_u32 s31, s31, 32768
    s_add_u32 s33, s33, 1024
    s_mov_b32 m0, s33
    s_nop 0
    buffer_load_dwordx4 v20, s[64:67], s31 offen lds
    s_add_u32 s31, s31, 32768
    s_add_u32 s33, s33, 1024
    s_cmp_lg_u32 s3, 4
    s_cbranch_scc1 T_NWO_2
    v_mul_u32_u24 v4, 57, v1
    v_lshrrev_b32 v4, 9, v4
    v_mul_u32_u24 v5, 9, v4
    v_sub_u32 v5, v1, v5
    s_movk_i32 s50, 1152
    v_mul_lo_u32 v21, v4, s50
    v_lshl_add_u32 v21, v5, 4, v21
    s_mul_i32 s31, s28, 147456
    s_mul_i32 s32, s29, 144
    s_add_u32 s31, s31, s32
    s_mov_b32 s33, 49152
    s_mov_b32 s46, -1
    s_mov_b32 s47, 0x7fffffff
    s_mov_b64 exec, s[46:47]
    s_mov_b32 m0, s33
    s_nop 0
    buffer_load_dwordx4 v21, s[68:71], s31 offen lds
    s_add_u32 s31, s31, 8064
    s_add_u32 s33, s33, 1008
    s_mov_b32 m0, s33
    s_nop 0
    buffer_load_dwordx4 v21, s[68:71], s31 offen lds
    s_add_u32 s31, s31, 8064
    s_add_u32 s33, s33, 1008
    s_mov_b32 m0, s33
    s_nop 0
    buffer_load_dwordx4 v21, s[68:71], s31 offen lds
    s_add_u32 s31, s31, 8064
    s_add_u32 s33, s33, 1008
    s_mov_b32 m0, s33
    s_nop 0
    buffer_load_dwordx4 v21, s[68:71], s31 offen lds
    s_add_u32 s31, s31, 8064
    s_add_u32 s33, s33, 1008
    s_mov_b32 m0, s33
    s_nop 0
    buffer_load_dwordx4 v21, s[68:71], s31 offen lds
    s_add_u32 s31, s31, 8064
    s_add_u32 s33, s33, 1008
    s_mov_b32 m0, s33
    s_nop 0
    buffer_load_dwordx4 v21, s[68:71], s31 offen lds
    s_add_u32 s31, s31, 8064
    s_add_u32 s33, s33, 1008
    s_mov_b32 m0, s33
    s_nop 0
    buffer_load_dwordx4 v21, s[68:71], s31 offen lds
    s_add_u32 s31, s31, 8064
    s_add_u32 s33, s33, 1008
    s_mov_b32 m0, s33
    s_nop 0
    buffer_load_dwordx4 v21, s[68:71], s31 offen lds
    s_add_u32 s31, s31, 8064
    s_add_u32 s33, s33, 1008
    s_mov_b32 m0, s33
    s_nop 0
    buffer_load_dwordx4 v21, s[68:71], s31 offen lds
    s_add_u32 s31, s31, 8064
    s_add_u32 s33, s33, 1008
    s_mov_b32 m0, s33
    s_nop 0
    buffer_load_dwordx4 v21, s[68:71], s31 offen lds
    s_add_u32 s31, s31, 8064
    s_add_u32 s33, s33, 1008
    s_mov_b32 m0, s33
    s_nop 0
    buffer_load_dwordx4 v21, s[68:71], s31 offen lds
    s_add_u32 s31, s31, 8064
    s_add_u32 s33, s33, 1008
    s_mov_b32 m0, s33
    s_nop 0
    buffer_load_dwordx4 v21, s[68:71], s31 offen lds
    s_add_u32 s31, s31, 8064
    s_add_u32 s33, s33, 1008
    s_mov_b32 m0, s33
    s_nop 0
    buffer_load_dwordx4 v21, s[68:71], s31 offen lds
    s_add_u32 s31, s31, 8064
    s_add_u32 s33, s33, 1008
    s_mov_b32 m0, s33
    s_nop 0
    buffer_load_dwordx4 v21, s[68:71], s31 offen lds
    s_add_u32 s31, s31, 8064
    s_add_u32 s33, s33, 1008
    s_mov_b32 m0, s33
    s_nop 0
    buffer_load_dwordx4 v21, s[68:71], s31 offen lds
    s_add_u32 s31, s31, 8064
    s_add_u32 s33, s33, 1008
    s_mov_b32 m0, s33
    s_nop 0
    buffer_load_dwordx4 v21, s[68:71], s31 offen lds
    s_add_u32 s31, s31, 8064
    s_add_u32 s33, s33, 1008
    s_mov_b32 m0, s33
    s_nop 0
    buffer_load_dwordx4 v21, s[68:71], s31 offen lds
    s_add_u32 s31, s31, 8064
    s_add_u32 s33, s33, 1008
    s_mov_b32 m0, s33
    s_nop 0
    buffer_load_dwordx4 v21, s[68:71], s31 offen lds
    s_add_u32 s31, s31, 8064
    s_add_u32 s33, s33, 1008
    s_mov_b64 exec, 0x3ffff
    s_mov_b32 m0, s33
    s_nop 0
    buffer_load_dwordx4 v21, s[68:71], s31 offen lds
    s_add_u32 s31, s31, 8064
    s_add_u32 s33, s33, 1008
    s_mov_b64 exec, -1
T_NWO_2:
    s_cmp_gt_u32 s51, 1
    s_cbranch_scc1 T_NW_3
    s_cmp_eq_u32 s3, 4
    s_cbranch_scc1 T_Q4_4
    s_waitcnt vmcnt(6)
    s_branch T_Q4D_5
T_Q4_4:
    s_waitcnt vmcnt(25)
T_Q4D_5:
    v_max_f32 v12, v8, v10
    s_nop 1
    v_max_f32_dpp v12, v12, v12 row_shr:1 row_mask:0xf bank_mask:0xf
    s_nop 1
    v_max_f32_dpp v12, v12, v12 row_shr:2 row_mask:0xf bank_mask:0xf
    s_nop 1
    v_max_f32_dpp v12, v12, v12 row_shr:4 row_mask:0xf bank_mask:0xf
    s_nop 1
    v_max_f32_dpp v12, v12, v12 row_shr:8 row_mask:0xf bank_mask:0xf
    s_nop 1
    v_max_f32_dpp v12, v12, v12 row_bcast:15 row_mask:0xa bank_mask:0xf
    s_nop 1
    v_max_f32_dpp v12, v12, v12 row_bcast:31 row_mask:0xc bank_mask:0xf
    s_nop 1
    v_readlane_b32 s34, v12, 63
    s_nop 3
    v_subrev_f32 v8, s34, v8
    v_subrev_f32 v10, s34, v10
    v_exp_f32 v8, v8
    v_exp_f32 v10, v10
    s_nop 0
    v_mul_f32 v12, v8, v9
    v_fmac_f32 v12, v10, v11
    s_nop 1
    v_add_f32_dpp v12, v12, v12 row_shr:1 row_mask:0xf bank_mask:0xf
    s_nop 1
    v_add_f32_dpp v12, v12, v12 row_shr:2 row_mask:0xf bank_mask:0xf
    s_nop 1
    v_add_f32_dpp v12, v12, v12 row_shr:4 row_mask:0xf bank_mask:0xf
    s_nop 1
    v_add_f32_dpp v12, v12, v12 row_shr:8 row_mask:0xf bank_mask:0xf
    s_nop 1
    v_add_f32_dpp v12, v12, v12 row_bcast:15 row_mask:0xa bank_mask:0xf
    s_nop 1
    v_add_f32_dpp v12, v12, v12 row_bcast:31 row_mask:0xc bank_mask:0xf
    s_nop 1
    v_readlane_b32 s34, v12, 63
    s_nop 3
    v_mov_b32 v12, s34
    v_rcp_f32 v13, v12
    s_nop 0
    v_fma_f32 v14, -v12, v13, 1.0
    v_fma_f32 v13, v14, v13, v13
    v_mul_f32 v8, v8, v13
    v_mul_f32 v10, v10, v13
    v_cvt_pk_bf16_f32 v12, v8, v8
    v_and_b32 v13, 0xffff0000, v12
    v_sub_f32 v13, v8, v13
    v_cvt_pk_bf16_f32 v13, v13, v13
    v_cvt_pk_bf16_f32 v14, v10, v10
    v_and_b32 v15, 0xffff0000, v14
    v_sub_f32 v15, v10, v15
    v_cvt_pk_bf16_f32 v15, v15, v15
    s_lshl_b32 s33, s51, 9
    s_add_u32 s33, s33, 138240
    v_lshl_add_u32 v9, v1, 1, s33
    ds_write_b16 v9, v12
    ds_write_b16 v9, v14 offset:128
    ds_write_b16 v9, v13 offset:256
    ds_write_b16 v9, v15 offset:384
T_NW_3:
    s_and_b32 s32, s3, 3
    v_mov_b32 v8, s32
    v_lshrrev_b32 v4, 4, v1
    v_bfe_u32 v5, v1, 2, 2
    v_lshl_add_u32 v4, v4, 3, v5
    v_bfe_u32 v5, v4, 1, 1
    v_bfe_u32 v6, v4, 3, 1
    v_lshl_or_b32 v5, v6, 1, v5
    v_xor_b32 v5, v5, v8
    v_lshlrev_b32 v5, 5, v5
    s_mov_b32 s50, 128
    v_mul_lo_u32 v48, v4, s50
    v_add_u32 v48, v48, v5
    v_and_b32 v5, 3, v1
    v_lshl_add_u32 v48, v5, 3, v48
    v_add_u32 v4, 4, v4
    v_bfe_u32 v5, v4, 1, 1
    v_bfe_u32 v6, v4, 3, 1
    v_lshl_or_b32 v5, v6, 1, v5
    v_xor_b32 v5, v5, v8
    v_lshlrev_b32 v5, 5, v5
    s_mov_b32 s50, 128
    v_mul_lo_u32 v49, v4, s50
    v_add_u32 v49, v49, v5
    v_and_b32 v5, 3, v1
    v_lshl_add_u32 v49, v5, 3, v49
    s_lshr_b32 s31, s3, 2
    s_lshl_b32 s33, s31, 14
    v_add_u32 v48, s33, v48
    v_add_u32 v49, s33, v49
    v_and_b32 v50, 15, v1
    v_min_u32 v50, 1, v50
    s_mov_b32 s50, 256
    v_mul_lo_u32 v50, v50, s50
    v_lshrrev_b32 v4, 4, v1
    v_lshl_add_u32 v50, v4, 4, v50
    v_add_u32 v50, 0x21c00, v50
    s_lshl_b32 s33, s31, 9
    v_add_u32 v50, s33, v50
    v_mov_b32 v8, s3
    v_lshrrev_b32 v4, 4, v1
    v_bfe_u32 v5, v1, 2, 2
    v_lshl_add_u32 v4, v4, 3, v5
    v_and_b32 v5, 3, v4
    v_bfe_u32 v6, v4, 3, 1
    v_lshl_or_b32 v5, v6, 2, v5
    v_xor_b32 v5, v5, v8
    v_lshlrev_b32 v5, 5, v5
    s_mov_b32 s50, 256
    v_mul_lo_u32 v56, v4, s50
    v_add_u32 v56, v56, v5
    v_and_b32 v5, 3, v1
    v_lshl_add_u32 v56, v5, 3, v56
    v_add_u32 v56, 0x8000, v56
    v_add_u32 v4, 4, v4
    v_and_b32 v5, 3, v4
    v_bfe_u32 v6, v4, 3, 1
    v_lshl_or_b32 v5, v6, 2, v5
    v_xor_b32 v5, v5, v8
    v_lshlrev_b32 v5, 5, v5
    s_mov_b32 s50, 256
    v_mul_lo_u32 v57, v4, s50
    v_add_u32 v57, v57, v5
    v_and_b32 v5, 3, v1
    v_lshl_add_u32 v57, v5, 3, v57
    v_add_u32 v57, 0x8000, v57
    v_and_b32 v58, 15, v1
    v_min_u32 v58, 3, v58
    s_mov_b32 s50, 128
    v_mul_lo_u32 v58, v58, s50
    v_lshrrev_b32 v4, 4, v1
    v_lshl_add_u32 v58, v4, 4, v58
    v_add_u32 v58, 0x22000, v58
    s_cmp_eq_u32 s3, 4
    s_cbranch_scc1 T_Q5_6
    s_waitcnt vmcnt(0)
    s_branch T_Q5D_7
T_Q5_6:
    s_waitcnt vmcnt(19)
T_Q5D_7:
    s_waitcnt lgkmcnt(0)
    s_barrier
    ds_read_b128 v[64:67], v50 offset:0
    ds_read_b64_tr_b16 v[96:97], v48 offset:0
    ds_read_b64_tr_b16 v[98:99], v49 offset:0
    ds_read_b128 v[68:71], v50 offset:64
    ds_read_b64_tr_b16 v[100:101], v48 offset:4096
    ds_read_b64_tr_b16 v[102:103], v49 offset:4096
    ds_read_b128 v[72:75], v50 offset:128
    ds_read_b64_tr_b16 v[104:105], v48 offset:8192
    ds_read_b64_tr_b16 v[106:107], v49 offset:8192
    ds_read_b128 v[76:79], v50 offset:192
    ds_read_b64_tr_b16 v[108:109], v48 offset:12288
    ds_read_b64_tr_b16 v[110:111], v49 offset:12288
    s_waitcnt lgkmcnt(9)
    v_mfma_f32_16x16x32_bf16 v[52:55], v[64:67], v[96:99], 0
    s_waitcnt lgkmcnt(6)
    v_mfma_f32_16x16x32_bf16 v[52:55], v[68:71], v[100:103], v[52:55]
    s_waitcnt lgkmcnt(3)
    v_mfma_f32_16x16x32_bf16 v[52:55], v[72:75], v[104:107], v[52:55]
    s_waitcnt lgkmcnt(0)
    v_mfma_f32_16x16x32_bf16 v[52:55], v[76:79], v[108:111], v[52:55]
    s_nop 7
    v_add_f32 v52, v52, v53
    v_cvt_pk_bf16_f32 v53, v52, v52
    v_and_b32 v54, 0xffff0000, v53
    v_sub_f32 v54, v52, v54
    v_cvt_pk_bf16_f32 v54, v54, v54
    s_lshl_b32 s33, s31, 7
    s_lshl_b32 s34, s32, 5
    s_add_u32 s33, s33, s34
    s_add_u32 s33, s33, 139264
    v_lshl_add_u32 v9, v1, 1, s33
    v_cmp_gt_u32 vcc, 16, v1
    s_and_saveexec_b64 s[42:43], vcc
    ds_write_b16 v9, v53
    ds_write_b16 v9, v54 offset:256
    s_mov_b64 exec, s[42:43]
    s_waitcnt lgkmcnt(0)
    s_barrier
    ds_read_b128 v[64:67], v58 offset:0
    ds_read_b64_tr_b16 v[96:97], v56 offset:0
    ds_read_b64_tr_b16 v[98:99], v57 offset:0
    ds_read_b128 v[68:71], v58 offset:64
    ds_read_b64_tr_b16 v[100:101], v56 offset:8192
    ds_read_b64_tr_b16 v[102:103], v57 offset:8192
    s_waitcnt lgkmcnt(3)
    v_mfma_f32_16x16x32_bf16 v[52:55], v[64:67], v[96:99], 0
    s_waitcnt lgkmcnt(0)
    v_mfma_f32_16x16x32_bf16 v[52:55], v[68:71], v[100:103], v[52:55]
    s_lshl_b32 s32, s28, 3
    s_add_u32 s32, s32, s29
    s_lshl_b32 s32, s32, 10
    s_lshl_b32 s33, s3, 6
    s_add_u32 s32, s32, s33
    s_add_u32 s32, s32, 0x40000
    v_lshlrev_b32 v9, 2, v1
    s_nop 4
    v_add_f32 v52, v52, v54
    v_add_f32 v53, v53, v55
    s_and_saveexec_b64 s[42:43], vcc
    buffer_store_dword v52, v9, s[24:27], s32 offen sc1
    buffer_store_dword v53, v9, s[24:27], s32 offen offset:512 sc1
    s_mov_b64 exec, s[42:43]
    s_cmp_ge_u32 s3, 4
    s_cbranch_scc1 T_LATE_8
    s_cmp_ge_u32 s2, 216
    s_cbranch_scc1 T_NGU_9
    s_mul_i32 s30, s2, 911
    s_lshr_b32 s30, s30, 16
    s_mul_i32 s31, s30, 72
    s_sub_u32 s31, s2, s31
    v_lshrrev_b32 v4, 3, v1
    v_and_b32 v5, 7, v1
    v_add_u32 v6, 0, v4
    v_bfe_u32 v22, v6, 1, 1
    v_bfe_u32 v6, v6, 3, 1
    v_lshl_or_b32 v22, v6, 1, v22
    v_lshlrev_b32 v22, 1, v22
    v_xor_b32 v22, v22, v5
    v_lshlrev_b32 v22, 4, v22
    s_mov_b32 s50, 9216
    v_mul_lo_u32 v6, v4, s50
    v_add_u32 v22, v22, v6
    v_add_u32 v6, 8, v4
    v_bfe_u32 v23, v6, 1, 1
    v_bfe_u32 v6, v6, 3, 1
    v_lshl_or_b32 v23, v6, 1, v23
    v_lshlrev_b32 v23, 1, v23
    v_xor_b32 v23, v23, v5
    v_lshlrev_b32 v23, 4, v23
    s_mov_b32 s50, 9216
    v_mul_lo_u32 v6, v4, s50
    v_add_u32 v23, v23, v6
    s_and_b32 s32, s3, 1
    s_mul_i32 s32, s32, 96
    s_mul_i32 s33, s30, 192
    s_add_u32 s32, s32, s33
    s_mul_i32 s32, s32, 9216
    s_lshl_b32 s33, s31, 7
    s_add_u32 s32, s32, s33
    s_mul_i32 s33, s3, 12288
    s_add_u32 s33, s33, 67584
    s_cmp_ge_u32 s3, 2
    s_cbranch_scc1 T_UP_10
    s_mov_b32 m0, s33
    s_nop 0
    buffer_load_dwordx4 v22, s[16:19], s32 offen lds
    s_waitcnt vmcnt(4)
    s_add_u32 s32, s32, 73728
    s_add_u32 s33, s33, 1024
    s_mov_b32 m0, s33
    s_nop 0
    buffer_load_dwordx4 v23, s[16:19], s32 offen lds
    s_waitcnt vmcnt(4)
    s_add_u32 s32, s32, 73728
    s_add_u32 s33, s33, 1024
    s_mov_b32 m0, s33
    s_nop 0
    buffer_load_dwordx4 v22, s[16:19], s32 offen lds
    s_waitcnt vmcnt(4)
    s_add_u32 s32, s32, 73728
    s_add_u32 s33, s33, 1024
    s_mov_b32 m0, s33
    s_nop 0
    buffer_load_dwordx4 v23, s[16:19], s32 offen lds
    s_waitcnt vmcnt(4)
    s_add_u32 s32, s32, 73728
    s_add_u32 s33, s33, 1024
    s_mov_b32 m0, s33
    s_nop 0
    buffer_load_dwordx4 v22, s[16:19], s32 offen lds
    s_waitcnt vmcnt(4)
    s_add_u32 s32, s32, 73728
    s_add_u32 s33, s33, 1024
    s_mov_b32 m0, s33
    s_nop 0
    buffer_load_dwordx4 v23, s[16:19], s32 offen lds
    s_waitcnt vmcnt(4)
    s_add_u32 s32, s32, 73728
    s_add_u32 s33, s33, 1024
    s_mov_b32 m0, s33
    s_nop 0
    buffer_load_dwordx4 v22, s[16:19], s32 offen lds
    s_waitcnt vmcnt(4)
    s_add_u32 s32, s32, 73728
    s_add_u32 s33, s33, 1024
    s_mov_b32 m0, s33
    s_nop 0
    buffer_load_dwordx4 v23, s[16:19], s32 offen lds
    s_waitcnt vmcnt(4)
    s_add_u32 s32, s32, 73728
    s_add_u32 s33, s33, 1024
    s_mov_b32 m0, s33
    s_nop 0
    buffer_load_dwordx4 v22, s[16:19], s32 offen lds
    s_waitcnt vmcnt(4)
    s_add_u32 s32, s32, 73728
    s_add_u32 s33, s33, 1024
    s_mov_b32 m0, s33
    s_nop 0
    buffer_load_dwordx4 v23, s[16:19], s32 offen lds
    s_waitcnt vmcnt(4)
    s_add_u32 s32, s32, 73728
    s_add_u32 s33, s33, 1024
    s_mov_b32 m0, s33
    s_nop 0
    buffer_load_dwordx4 v22, s[16:19], s32 offen lds
    s_waitcnt vmcnt(4)
    s_add_u32 s32, s32, 73728
    s_add_u32 s33, s33, 1024
    s_mov_b32 m0, s33
    s_nop 0
    buffer_load_dwordx4 v23, s[16:19], s32 offen lds
    s_waitcnt vmcnt(4)
    s_add_u32 s32, s32, 73728
    s_add_u32 s33, s33, 1024
    s_branch T_GD_11
T_UP_10:
    s_mov_b32 m0, s33
    s_nop 0
    buffer_load_dwordx4 v22, s[20:23], s32 offen lds
    s_waitcnt vmcnt(4)
    s_add_u32 s32, s32, 73728
    s_add_u32 s33, s33, 1024
    s_mov_b32 m0, s33
    s_nop 0
    buffer_load_dwordx4 v23, s[20:23], s32 offen lds
    s_waitcnt vmcnt(4)
    s_add_u32 s32, s32, 73728
    s_add_u32 s33, s33, 1024
    s_mov_b32 m0, s33
    s_nop 0
    buffer_load_dwordx4 v22, s[20:23], s32 offen lds
    s_waitcnt vmcnt(4)
    s_add_u32 s32, s32, 73728
    s_add_u32 s33, s33, 1024
    s_mov_b32 m0, s33
    s_nop 0
    buffer_load_dwordx4 v23, s[20:23], s32 offen lds
    s_waitcnt vmcnt(4)
    s_add_u32 s32, s32, 73728
    s_add_u32 s33, s33, 1024
    s_mov_b32 m0, s33
    s_nop 0
    buffer_load_dwordx4 v22, s[20:23], s32 offen lds
    s_waitcnt vmcnt(4)
    s_add_u32 s32, s32, 73728
    s_add_u32 s33, s33, 1024
    s_mov_b32 m0, s33
    s_nop 0
    buffer_load_dwordx4 v23, s[20:23], s32 offen lds
    s_waitcnt vmcnt(4)
    s_add_u32 s32, s32, 73728
    s_add_u32 s33, s33, 1024
    s_mov_b32 m0, s33
    s_nop 0
    buffer_load_dwordx4 v22, s[20:23], s32 offen lds
    s_waitcnt vmcnt(4)
    s_add_u32 s32, s32, 73728
    s_add_u32 s33, s33, 1024
    s_mov_b32 m0, s33
    s_nop 0
    buffer_load_dwordx4 v23, s[20:23], s32 offen lds
    s_waitcnt vmcnt(4)
    s_add_u32 s32, s32, 73728
    s_add_u32 s33, s33, 1024
    s_mov_b32 m0, s33
    s_nop 0
    buffer_load_dwordx4 v22, s[20:23], s32 offen lds
    s_waitcnt vmcnt(4)
    s_add_u32 s32, s32, 73728
    s_add_u32 s33, s33, 1024
    s_mov_b32 m0, s33
    s_nop 0
    buffer_load_dwordx4 v23, s[20:23], s32 offen lds
    s_waitcnt vmcnt(4)
    s_add_u32 s32, s32, 73728
    s_add_u32 s33, s33, 1024
    s_mov_b32 m0, s33
    s_nop 0
    buffer_load_dwordx4 v22, s[20:23], s32 offen lds
    s_waitcnt vmcnt(4)
    s_add_u32 s32, s32, 73728
    s_add_u32 s33, s33, 1024
    s_mov_b32 m0, s33
    s_nop 0
    buffer_load_dwordx4 v23, s[20:23], s32 offen lds
    s_waitcnt vmcnt(4)
    s_add_u32 s32, s32, 73728
    s_add_u32 s33, s33, 1024
T_GD_11:
T_NGU_9:
    v_mul_u32_u24 v4, 57, v1
    v_lshrrev_b32 v4, 9, v4
    v_mul_u32_u24 v5, 9, v4
    v_sub_u32 v5, v1, v5
    s_movk_i32 s50, 1152
    v_mul_lo_u32 v24, v4, s50
    v_lshl_add_u32 v24, v5, 4, v24
    s_mul_i32 s32, s28, 144
    s_mul_i32 s33, s3, 7
    s_add_u32 s32, s32, s33
    s_mul_i32 s32, s32, 1152
    s_mul_i32 s33, s29, 144
    s_add_u32 s32, s32, s33
    s_mul_i32 s33, s3, 1008
    s_add_u32 s33, s33, 116736
    s_mov_b32 s46, -1
    s_mov_b32 s47, 0x7fffffff
    s_mov_b64 exec, s[46:47]
    s_mov_b32 m0, s33
    s_nop 0
    buffer_load_dwordx4 v24, s[36:39], s32 offen lds
    s_waitcnt vmcnt(4)
    s_add_u32 s32, s32, 32256
    s_add_u32 s33, s33, 4032
    s_mov_b32 m0, s33
    s_nop 0
    buffer_load_dwordx4 v24, s[36:39], s32 offen lds
    s_waitcnt vmcnt(4)
    s_add_u32 s32, s32, 32256
    s_add_u32 s33, s33, 4032
    s_mov_b32 m0, s33
    s_nop 0
    buffer_load_dwordx4 v24, s[36:39], s32 offen lds
    s_waitcnt vmcnt(4)
    s_add_u32 s32, s32, 32256
    s_add_u32 s33, s33, 4032
    s_mov_b32 m0, s33
    s_nop 0
    buffer_load_dwordx4 v24, s[36:39], s32 offen lds
    s_waitcnt vmcnt(4)
    s_add_u32 s32, s32, 32256
    s_add_u32 s33, s33, 4032
    s_mov_b32 m0, s33
    s_nop 0
    buffer_load_dwordx4 v24, s[36:39], s32 offen lds
    s_waitcnt vmcnt(4)
    s_add_u32 s32, s32, 32256
    s_add_u32 s33, s33, 4032
    s_cmp_lg_u32 s3, 0
    s_cbranch_scc1 T_D6_12
    s_mov_b32 s47, 0xf
    s_mov_b64 exec, s[46:47]
    s_mov_b32 m0, s33
    s_nop 0
    buffer_load_dwordx4 v24, s[36:39], s32 offen lds
    s_waitcnt vmcnt(4)
T_D6_12:
    s_add_u32 s32, s32, 32256
    s_add_u32 s33, s33, 4032
    s_mov_b64 exec, -1
T_LATE_8:
    s_cmp_lg_u32 s3, 4
    s_cbranch_scc1 T_NOP4_13
    v_lshlrev_b32 v3, 4, v1
    s_lshl_b32 s30, s28, 13
    s_add_u32 s30, s30, 0x40000
    s_add_u32 s31, s30, 4096
    v_lshrrev_b32 v4, 4, v1
    v_bfe_u32 v5, v1, 2, 2
    v_lshl_add_u32 v4, v4, 3, v5
    s_movk_i32 s50, 144
    v_mul_lo_u32 v48, v4, s50
    v_and_b32 v5, 3, v1
    v_lshl_add_u32 v48, v5, 3, v48
    v_add_u32 v48, 49152, v48
    v_and_b32 v50, 15, v1
    v_min_u32 v50, 1, v50
    s_mov_b32 s50, 256
    v_mul_lo_u32 v50, v50, s50
    v_lshrrev_b32 v4, 4, v1
    v_lshl_add_u32 v50, v4, 4, v50
    v_add_u32 v50, 0x22200, v50
    s_lshl_b32 s32, s28, 7
    s_add_u32 s32, s32, 0xd0000
    s_mul_i32 s33, s29, 72
    v_add_u32 v4, s33, v1
    v_add_u32 v4, 0, v4
    v_lshrrev_b32 v112, 5, v4
    v_lshlrev_b32 v112, 12, v112
    v_and_b32 v4, 31, v4
    v_lshl_add_u32 v112, v4, 2, v112
    v_add_u32 v4, s33, v1
    v_add_u32 v4, 576, v4
    v_lshrrev_b32 v113, 5, v4
    v_lshlrev_b32 v113, 12, v113
    v_and_b32 v4, 31, v4
    v_lshl_add_u32 v113, v4, 2, v113
    v_add_u32 v4, s33, v1
    v_add_u32 v4, 16, v4
    v_lshrrev_b32 v114, 5, v4
    v_lshlrev_b32 v114, 12, v114
    v_and_b32 v4, 31, v4
    v_lshl_add_u32 v114, v4, 2, v114
    v_add_u32 v4, s33, v1
    v_add_u32 v4, 592, v4
    v_lshrrev_b32 v115, 5, v4
    v_lshlrev_b32 v115, 12, v115
    v_and_b32 v4, 31, v4
    v_lshl_add_u32 v115, v4, 2, v115
    v_add_u32 v4, s33, v1
    v_add_u32 v4, 32, v4
    v_lshrrev_b32 v116, 5, v4
    v_lshlrev_b32 v116, 12, v116
    v_and_b32 v4, 31, v4
    v_lshl_add_u32 v116, v4, 2, v116
    v_add_u32 v4, s33, v1
    v_add_u32 v4, 608, v4
    v_lshrrev_b32 v117, 5, v4
    v_lshlrev_b32 v117, 12, v117
    v_and_b32 v4, 31, v4
    v_lshl_add_u32 v117, v4, 2, v117
    v_add_u32 v4, s33, v1
    v_add_u32 v4, 48, v4
    v_lshrrev_b32 v118, 5, v4
    v_lshlrev_b32 v118, 12, v118
    v_and_b32 v4, 31, v4
    v_lshl_add_u32 v118, v4, 2, v118
    v_add_u32 v4, s33, v1
    v_add_u32 v4, 624, v4
    v_lshrrev_b32 v119, 5, v4
    v_lshlrev_b32 v119, 12, v119
    v_and_b32 v4, 31, v4
    v_lshl_add_u32 v119, v4, 2, v119
    v_add_u32 v4, s33, v1
    v_add_u32 v4, 64, v4
    v_lshrrev_b32 v120, 5, v4
    v_lshlrev_b32 v120, 12, v120
    v_and_b32 v4, 31, v4
    v_lshl_add_u32 v120, v4, 2, v120
    v_add_u32 v4, s33, v1
    v_add_u32 v4, 640, v4
    v_lshrrev_b32 v121, 5, v4
    v_lshlrev_b32 v121, 12, v121
    v_and_b32 v4, 31, v4
    v_lshl_add_u32 v121, v4, 2, v121
    s_waitcnt vmcnt(0)
    ds_read_b64_tr_b16 v[128:129], v48 offset:0
    ds_read_b64_tr_b16 v[130:131], v48 offset:576
    ds_read_b64_tr_b16 v[132:133], v48 offset:4608
    ds_read_b64_tr_b16 v[134:135], v48 offset:5184
    ds_read_b64_tr_b16 v[136:137], v48 offset:9216
    ds_read_b64_tr_b16 v[138:139], v48 offset:9792
    ds_read_b64_tr_b16 v[140:141], v48 offset:13824
    ds_read_b64_tr_b16 v[142:143], v48 offset:14400
    ds_read_b64_tr_b16 v[144:145], v48 offset:32
    ds_read_b64_tr_b16 v[146:147], v48 offset:608
    ds_read_b64_tr_b16 v[148:149], v48 offset:4640
    ds_read_b64_tr_b16 v[150:151], v48 offset:5216
    ds_read_b64_tr_b16 v[152:153], v48 offset:9248
    ds_read_b64_tr_b16 v[154:155], v48 offset:9824
    ds_read_b64_tr_b16 v[156:157], v48 offset:13856
    ds_read_b64_tr_b16 v[158:159], v48 offset:14432
    ds_read_b64_tr_b16 v[160:161], v48 offset:64
    ds_read_b64_tr_b16 v[162:163], v48 offset:640
    ds_read_b64_tr_b16 v[164:165], v48 offset:4672
    ds_read_b64_tr_b16 v[166:167], v48 offset:5248
    ds_read_b64_tr_b16 v[168:169], v48 offset:9280
    ds_read_b64_tr_b16 v[170:171], v48 offset:9856
    ds_read_b64_tr_b16 v[172:173], v48 offset:13888
    ds_read_b64_tr_b16 v[174:175], v48 offset:14464
    ds_read_b64_tr_b16 v[176:177], v48 offset:96
    ds_read_b64_tr_b16 v[178:179], v48 offset:672
    ds_read_b64_tr_b16 v[180:181], v48 offset:4704
    ds_read_b64_tr_b16 v[182:183], v48 offset:5280
    ds_read_b64_tr_b16 v[184:185], v48 offset:9312
    ds_read_b64_tr_b16 v[186:187], v48 offset:9888
    ds_read_b64_tr_b16 v[188:189], v48 offset:13920
    ds_read_b64_tr_b16 v[190:191], v48 offset:14496
    ds_read_b64_tr_b16 v[192:193], v48 offset:128
    ds_read_b64_tr_b16 v[194:195], v48 offset:704
    ds_read_b64_tr_b16 v[196:197], v48 offset:4736
    ds_read_b64_tr_b16 v[198:199], v48 offset:5312
    ds_read_b64_tr_b16 v[200:201], v48 offset:9344
    ds_read_b64_tr_b16 v[202:203], v48 offset:9920
    ds_read_b64_tr_b16 v[204:205], v48 offset:13952
    ds_read_b64_tr_b16 v[206:207], v48 offset:14528
    s_mov_b32 s52, 0
T_E3_14:
    s_sleep 6
    buffer_load_dwordx4 v[8:11], v3, s[24:27], s30 offen offset:0 sc1
    buffer_load_dwordx4 v[12:15], v3, s[24:27], s30 offen offset:1024 sc1
    buffer_load_dwordx4 v[16:19], v3, s[24:27], s30 offen offset:2048 sc1
    buffer_load_dwordx4 v[20:23], v3, s[24:27], s30 offen offset:3072 sc1
    buffer_load_dwordx4 v[24:27], v3, s[24:27], s31 offen offset:0 sc1
    buffer_load_dwordx4 v[28:31], v3, s[24:27], s31 offen offset:1024 sc1
    buffer_load_dwordx4 v[32:35], v3, s[24:27], s31 offen offset:2048 sc1
    buffer_load_dwordx4 v[36:39], v3, s[24:27], s31 offen offset:3072 sc1
    s_waitcnt vmcnt(0)
    v_max3_u32 v40, v8, v9, v10
    v_max3_u32 v40, v40, v11, v12
    v_max3_u32 v40, v40, v13, v14
    v_max3_u32 v40, v40, v15, v16
    v_max3_u32 v40, v40, v17, v18
    v_max3_u32 v40, v40, v19, v20
    v_max3_u32 v40, v40, v21, v22
    v_max3_u32 v40, v40, v23, v24
    v_max3_u32 v40, v40, v25, v26
    v_max3_u32 v40, v40, v27, v28
    v_max3_u32 v40, v40, v29, v30
    v_max3_u32 v40, v40, v31, v32
    v_max3_u32 v40, v40, v33, v34
    v_max3_u32 v40, v40, v35, v36
    v_max3_u32 v40, v40, v37, v38
    v_max_u32 v40, v40, v39
    v_cmp_eq_u32 vcc, -1, v40
    s_add_u32 s52, s52, 1
    s_cmp_gt_u32 s52, 200000
    s_cbranch_scc1 T_E3D_15
    s_cbranch_vccnz T_E3_14
T_E3D_15:
    v_add_f32 v8, v8, v12
    v_add_f32 v9, v9, v13
    v_add_f32 v10, v10, v14
    v_add_f32 v11, v11, v15
    v_add_f32 v8, v8, v16
    v_add_f32 v9, v9, v17
    v_add_f32 v10, v10, v18
    v_add_f32 v11, v11, v19
    v_add_f32 v8, v8, v20
    v_add_f32 v9, v9, v21
    v_add_f32 v10, v10, v22
    v_add_f32 v11, v11, v23
    v_add_f32 v8, v8, v24
    v_add_f32 v9, v9, v25
    v_add_f32 v10, v10, v26
    v_add_f32 v11, v11, v27
    v_add_f32 v8, v8, v28
    v_add_f32 v9, v9, v29
    v_add_f32 v10, v10, v30
    v_add_f32 v11, v11, v31
    v_add_f32 v8, v8, v32
    v_add_f32 v9, v9, v33
    v_add_f32 v10, v10, v34
    v_add_f32 v11, v11, v35
    v_add_f32 v8, v8, v36
    v_add_f32 v9, v9, v37
    v_add_f32 v10, v10, v38
    v_add_f32 v11, v11, v39
    v_cvt_pk_bf16_f32 v8, v8, v9
    v_cvt_pk_bf16_f32 v9, v10, v11
    v_lshlrev_b32 v10, 3, v1
    v_add_u32 v10, 139776, v10
    ds_write_b64 v10, v[8:9]
    s_waitcnt lgkmcnt(0)
    ds_read_b128 v[64:67], v50 offset:0
    ds_read_b128 v[68:71], v50 offset:64
    ds_read_b128 v[72:75], v50 offset:128
    ds_read_b128 v[76:79], v50 offset:192
    s_waitcnt lgkmcnt(3)
    v_mfma_f32_16x16x32_bf16 v[8:11], v[64:67], v[128:131], 0
    v_mfma_f32_16x16x32_bf16 v[12:15], v[64:67], v[144:147], 0
    v_mfma_f32_16x16x32_bf16 v[16:19], v[64:67], v[160:163], 0
    v_mfma_f32_16x16x32_bf16 v[20:23], v[64:67], v[176:179], 0
    v_mfma_f32_16x16x32_bf16 v[24:27], v[64:67], v[192:195], 0
    s_waitcnt lgkmcnt(2)
    v_mfma_f32_16x16x32_bf16 v[8:11], v[68:71], v[132:135], v[8:11]
    v_mfma_f32_16x16x32_bf16 v[12:15], v[68:71], v[148:151], v[12:15]
    v_mfma_f32_16x16x32_bf16 v[16:19], v[68:71], v[164:167], v[16:19]
    v_mfma_f32_16x16x32_bf16 v[20:23], v[68:71], v[180:183], v[20:23]
    v_mfma_f32_16x16x32_bf16 v[24:27], v[68:71], v[196:199], v[24:27]
    s_waitcnt lgkmcnt(1)
    v_mfma_f32_16x16x32_bf16 v[8:11], v[72:75], v[136:139], v[8:11]
    v_mfma_f32_16x16x32_bf16 v[12:15], v[72:75], v[152:155], v[12:15]
    v_mfma_f32_16x16x32_bf16 v[16:19], v[72:75], v[168:171], v[16:19]
    v_mfma_f32_16x16x32_bf16 v[20:23], v[72:75], v[184:187], v[20:23]
    v_mfma_f32_16x16x32_bf16 v[24:27], v[72:75], v[200:203], v[24:27]
    s_waitcnt lgkmcnt(0)
    v_mfma_f32_16x16x32_bf16 v[8:11], v[76:79], v[140:143], v[8:11]
    v_mfma_f32_16x16x32_bf16 v[12:15], v[76:79], v[156:159], v[12:15]
    v_mfma_f32_16x16x32_bf16 v[16:19], v[76:79], v[172:175], v[16:19]
    v_mfma_f32_16x16x32_bf16 v[20:23], v[76:79], v[188:191], v[20:23]
    v_mfma_f32_16x16x32_bf16 v[24:27], v[76:79], v[204:207], v[24:27]
    s_mov_b64 exec, 0xffff
    s_nop 7
    buffer_store_dword v8, v112, s[24:27], s32 offen sc1
    buffer_store_dword v9, v113, s[24:27], s32 offen sc1
    buffer_store_dword v12, v114, s[24:27], s32 offen sc1
    buffer_store_dword v13, v115, s[24:27], s32 offen sc1
    buffer_store_dword v16, v116, s[24:27], s32 offen sc1
    buffer_store_dword v17, v117, s[24:27], s32 offen sc1
    buffer_store_dword v20, v118, s[24:27], s32 offen sc1
    buffer_store_dword v21, v119, s[24:27], s32 offen sc1
    s_mov_b64 exec, 0xff
    buffer_store_dword v24, v120, s[24:27], s32 offen sc1
    buffer_store_dword v25, v121, s[24:27], s32 offen sc1
    s_mov_b64 exec, -1
T_NOP4_13:
    s_cmp_lg_u32 s3, 5
    s_cbranch_scc1 T_NORED_16
    s_cmp_ge_u32 s2, 36
    s_cbranch_scc1 T_NORED_16
    v_and_b32 v3, 31, v1
    s_lshl_b32 s30, s2, 5
    v_add_u32 v3, s30, v3
    v_lshlrev_b32 v6, 4, v1
    s_lshl_b32 s31, s2, 12
    s_add_u32 s31, s31, 0xd0000
    s_mov_b32 s52, 0
T_R1_17:
    s_sleep 6
    buffer_load_dwordx4 v[8:11], v6, s[24:27], s31 offen offset:0 sc1
    buffer_load_dwordx4 v[12:15], v6, s[24:27], s31 offen offset:1024 sc1
    buffer_load_dwordx4 v[16:19], v6, s[24:27], s31 offen offset:2048 sc1
    buffer_load_dwordx4 v[20:23], v6, s[24:27], s31 offen offset:3072 sc1
    s_waitcnt vmcnt(0)
    v_max3_u32 v30, v8, v9, v10
    v_max3_u32 v30, v30, v11, v12
    v_max3_u32 v30, v30, v13, v14
    v_max3_u32 v30, v30, v15, v16
    v_max3_u32 v30, v30, v17, v18
    v_max3_u32 v30, v30, v19, v20
    v_max3_u32 v30, v30, v21, v22
    v_max_u32 v30, v30, v23
    v_cmp_eq_u32 vcc, -1, v30
    s_add_u32 s52, s52, 1
    s_cmp_gt_u32 s52, 200000
    s_cbranch_scc1 T_R1D_18
    s_cbranch_vccnz T_R1_17
T_R1D_18:
    v_add_f32 v8, v8, v12
    v_add_f32 v16, v16, v20
    v_add_f32 v8, v8, v16
    v_add_f32 v9, v9, v13
    v_add_f32 v17, v17, v21
    v_add_f32 v9, v9, v17
    v_add_f32 v10, v10, v14
    v_add_f32 v18, v18, v22
    v_add_f32 v10, v10, v18
    v_add_f32 v11, v11, v15
    v_add_f32 v19, v19, v23
    v_add_f32 v11, v11, v19
    v_add_u32 v7, 143232, v6
    ds_write_b128 v7, v[8:11]
    v_and_b32 v7, 31, v1
    v_lshlrev_b32 v7, 2, v7
    v_add_u32 v7, 143232, v7
    s_waitcnt lgkmcnt(0)
    ds_read_b32 v8, v7 offset:0
    ds_read_b32 v9, v7 offset:128
    ds_read_b32 v10, v7 offset:256
    ds_read_b32 v11, v7 offset:384
    ds_read_b32 v12, v7 offset:512
    ds_read_b32 v13, v7 offset:640
    ds_read_b32 v14, v7 offset:768
    ds_read_b32 v15, v7 offset:896
    s_waitcnt lgkmcnt(0)
    v_add_f32 v8, v8, v9
    v_add_f32 v10, v10, v11
    v_add_f32 v12, v12, v13
    v_add_f32 v14, v14, v15
    v_add_f32 v8, v8, v10
    v_add_f32 v12, v12, v14
    v_add_f32 v8, v8, v12
    v_lshlrev_b32 v3, 2, v3
    s_mov_b32 s31, 0x10000
    s_mov_b64 exec, 0xffffffff
    buffer_store_dword v8, v3, s[24:27], s31 offen sc1
    s_mov_b64 exec, -1
T_NORED_16:
    s_cmp_lt_u32 s3, 6
    s_cbranch_scc1 T_NOLN_19
    s_sub_u32 s53, s3, 6
    v_mov_b32 v14, 0
    v_mov_b32 v24, 0
    v_mov_b32 v25, 0
    s_mul_i32 s30, s53, 1152
    v_lshlrev_b32 v3, 2, v1
    buffer_load_dword v10, v3, s[12:15], s30 offen offset:0
    buffer_load_dword v11, v3, s[12:15], s30 offen offset:256
    buffer_load_dword v12, v3, s[12:15], s30 offen offset:512
    buffer_load_dword v13, v3, s[12:15], s30 offen offset:768
    v_lshlrev_b32 v15, 3, v1
    s_lshl_b32 s31, s30, 1
    s_add_u32 s31, s31, 0x10000
    s_mov_b64 s[42:43], exec
    s_mov_b64 exec, s[44:45]
    buffer_load_dword v14, v3, s[12:15], s30 offen offset:1024
    s_mov_b64 exec, s[42:43]
    s_mov_b32 s52, 0
T_H_20:
    s_sleep 6
    buffer_load_dwordx2 v[16:17], v15, s[24:27], s31 offen offset:0 sc1
    buffer_load_dwordx2 v[18:19], v15, s[24:27], s31 offen offset:512 sc1
    buffer_load_dwordx2 v[20:21], v15, s[24:27], s31 offen offset:1024 sc1
    buffer_load_dwordx2 v[22:23], v15, s[24:27], s31 offen offset:1536 sc1
    s_mov_b64 exec, s[44:45]
    buffer_load_dwordx2 v[24:25], v15, s[24:27], s31 offen offset:2048 sc1
    s_mov_b64 exec, s[42:43]
    s_waitcnt vmcnt(0)
    v_max3_u32 v26, v16, v17, v18
    v_max3_u32 v26, v26, v19, v20
    v_max3_u32 v26, v26, v21, v22
    v_max3_u32 v26, v26, v23, v24
    v_max_u32 v26, v26, v25
    v_cmp_eq_u32 vcc, -1, v26
    s_add_u32 s52, s52, 1
    s_cmp_gt_u32 s52, 200000
    s_cbranch_scc1 T_HD_21
    s_cbranch_vccnz T_H_20
T_HD_21:
    v_lshlrev_b32 v28, 16, v10
    v_and_b32 v29, 0xffff0000, v10
    v_lshlrev_b32 v30, 16, v11
    v_and_b32 v31, 0xffff0000, v11
    v_lshlrev_b32 v32, 16, v12
    v_and_b32 v33, 0xffff0000, v12
    v_lshlrev_b32 v34, 16, v13
    v_and_b32 v35, 0xffff0000, v13
    v_lshlrev_b32 v36, 16, v14
    v_and_b32 v37, 0xffff0000, v14
    v_cvt_pk_bf16_f32 v16, v16, v16
    v_and_b32 v16, 0xffff0000, v16
    v_add_f32 v28, v28, v16
    v_cvt_pk_bf16_f32 v28, v28, v28
    v_and_b32 v28, 0xffff0000, v28
    v_cvt_pk_bf16_f32 v17, v17, v17
    v_and_b32 v17, 0xffff0000, v17
    v_add_f32 v29, v29, v17
    v_cvt_pk_bf16_f32 v29, v29, v29
    v_and_b32 v29, 0xffff0000, v29
    v_cvt_pk_bf16_f32 v18, v18, v18
    v_and_b32 v18, 0xffff0000, v18
    v_add_f32 v30, v30, v18
    v_cvt_pk_bf16_f32 v30, v30, v30
    v_and_b32 v30, 0xffff0000, v30
    v_cvt_pk_bf16_f32 v19, v19, v19
    v_and_b32 v19, 0xffff0000, v19
    v_add_f32 v31, v31, v19
    v_cvt_pk_bf16_f32 v31, v31, v31
    v_and_b32 v31, 0xffff0000, v31
    v_cvt_pk_bf16_f32 v20, v20, v20
    v_and_b32 v20, 0xffff0000, v20
    v_add_f32 v32, v32, v20
    v_cvt_pk_bf16_f32 v32, v32, v32
    v_and_b32 v32, 0xffff0000, v32
    v_cvt_pk_bf16_f32 v21, v21, v21
    v_and_b32 v21, 0xffff0000, v21
    v_add_f32 v33, v33, v21
    v_cvt_pk_bf16_f32 v33, v33, v33
    v_and_b32 v33, 0xffff0000, v33
    v_cvt_pk_bf16_f32 v22, v22, v22
    v_and_b32 v22, 0xffff0000, v22
    v_add_f32 v34, v34, v22
    v_cvt_pk_bf16_f32 v34, v34, v34
    v_and_b32 v34, 0xffff0000, v34
    v_cvt_pk_bf16_f32 v23, v23, v23
    v_and_b32 v23, 0xffff0000, v23
    v_add_f32 v35, v35, v23
    v_cvt_pk_bf16_f32 v35, v35, v35
    v_and_b32 v35, 0xffff0000, v35
    v_cvt_pk_bf16_f32 v24, v24, v24
    v_and_b32 v24, 0xffff0000, v24
    v_add_f32 v36, v36, v24
    v_cvt_pk_bf16_f32 v36, v36, v36
    v_and_b32 v36, 0xffff0000, v36
    v_cvt_pk_bf16_f32 v25, v25, v25
    v_and_b32 v25, 0xffff0000, v25
    v_add_f32 v37, v37, v25
    v_cvt_pk_bf16_f32 v37, v37, v37
    v_and_b32 v37, 0xffff0000, v37
    v_add_f32 v42, v28, v29
    v_add_f32 v42, v42, v30
    v_add_f32 v42, v42, v31
    v_add_f32 v42, v42, v32
    v_add_f32 v42, v42, v33
    v_add_f32 v42, v42, v34
    v_add_f32 v42, v42, v35
    v_add_f32 v42, v42, v36
    v_add_f32 v42, v42, v37
    s_nop 1
    v_add_f32_dpp v42, v42, v42 row_shr:1 row_mask:0xf bank_mask:0xf
    s_nop 1
    v_add_f32_dpp v42, v42, v42 row_shr:2 row_mask:0xf bank_mask:0xf
    s_nop 1
    v_add_f32_dpp v42, v42, v42 row_shr:4 row_mask:0xf bank_mask:0xf
    s_nop 1
    v_add_f32_dpp v42, v42, v42 row_shr:8 row_mask:0xf bank_mask:0xf
    s_nop 1
    v_add_f32_dpp v42, v42, v42 row_bcast:15 row_mask:0xa bank_mask:0xf
    s_nop 1
    v_add_f32_dpp v42, v42, v42 row_bcast:31 row_mask:0xc bank_mask:0xf
    s_nop 1
    v_readlane_b32 s40, v42, 63
    s_nop 3
    v_mov_b32 v43, s40
    v_mul_f32 v43, 0x3ae38e39, v43
    v_mov_b32 v42, 0
    v_sub_f32 v45, v28, v43
    v_fmac_f32 v42, v45, v45
    v_sub_f32 v45, v29, v43
    v_fmac_f32 v42, v45, v45
    v_sub_f32 v45, v30, v43
    v_fmac_f32 v42, v45, v45
    v_sub_f32 v45, v31, v43
    v_fmac_f32 v42, v45, v45
    v_sub_f32 v45, v32, v43
    v_fmac_f32 v42, v45, v45
    v_sub_f32 v45, v33, v43
    v_fmac_f32 v42, v45, v45
    v_sub_f32 v45, v34, v43
    v_fmac_f32 v42, v45, v45
    v_sub_f32 v45, v35, v43
    v_fmac_f32 v42, v45, v45
    v_sub_f32 v45, v36, v43
    v_cndmask_b32 v45, 0, v45, s[44:45]
    v_fmac_f32 v42, v45, v45
    v_sub_f32 v45, v37, v43
    v_cndmask_b32 v45, 0, v45, s[44:45]
    v_fmac_f32 v42, v45, v45
    s_nop 1
    v_add_f32_dpp v42, v42, v42 row_shr:1 row_mask:0xf bank_mask:0xf
    s_nop 1
    v_add_f32_dpp v42, v42, v42 row_shr:2 row_mask:0xf bank_mask:0xf
    s_nop 1
    v_add_f32_dpp v42, v42, v42 row_shr:4 row_mask:0xf bank_mask:0xf
    s_nop 1
    v_add_f32_dpp v42, v42, v42 row_shr:8 row_mask:0xf bank_mask:0xf
    s_nop 1
    v_add_f32_dpp v42, v42, v42 row_bcast:15 row_mask:0xa bank_mask:0xf
    s_nop 1
    v_add_f32_dpp v42, v42, v42 row_bcast:31 row_mask:0xc bank_mask:0xf
    s_nop 1
    v_readlane_b32 s40, v42, 63
    s_nop 3
    v_mov_b32 v46, s40
    v_mul_f32 v46, 0x3ae38e39, v46
    v_cvt_pk_bf16_f32 v46, v46, v46
    v_and_b32 v46, 0xffff0000, v46
    v_add_f32 v46, 0x3727c5ac, v46
    v_cvt_pk_bf16_f32 v46, v46, v46
    v_and_b32 v46, 0xffff0000, v46
    v_sqrt_f32 v46, v46
    s_nop 0
    v_cvt_pk_bf16_f32 v46, v46, v46
    v_and_b32 v46, 0xffff0000, v46
    v_rcp_f32 v44, v46
    v_cvt_pk_bf16_f32 v43, v43, v43
    v_and_b32 v43, 0xffff0000, v43
    v_sub_f32 v45, v28, v43
    v_cvt_pk_bf16_f32 v45, v45, v45
    v_and_b32 v45, 0xffff0000, v45
    v_mul_f32 v47, v45, v44
    v_fma_f32 v28, -v47, v46, v45
    v_fma_f32 v28, v28, v44, v47
    v_sub_f32 v45, v29, v43
    v_cvt_pk_bf16_f32 v45, v45, v45
    v_and_b32 v45, 0xffff0000, v45
    v_mul_f32 v47, v45, v44
    v_fma_f32 v29, -v47, v46, v45
    v_fma_f32 v29, v29, v44, v47
    v_sub_f32 v45, v30, v43
    v_cvt_pk_bf16_f32 v45, v45, v45
    v_and_b32 v45, 0xffff0000, v45
    v_mul_f32 v47, v45, v44
    v_fma_f32 v30, -v47, v46, v45
    v_fma_f32 v30, v30, v44, v47
    v_sub_f32 v45, v31, v43
    v_cvt_pk_bf16_f32 v45, v45, v45
    v_and_b32 v45, 0xffff0000, v45
    v_mul_f32 v47, v45, v44
    v_fma_f32 v31, -v47, v46, v45
    v_fma_f32 v31, v31, v44, v47
    v_sub_f32 v45, v32, v43
    v_cvt_pk_bf16_f32 v45, v45, v45
    v_and_b32 v45, 0xffff0000, v45
    v_mul_f32 v47, v45, v44
    v_fma_f32 v32, -v47, v46, v45
    v_fma_f32 v32, v32, v44, v47
    v_sub_f32 v45, v33, v43
    v_cvt_pk_bf16_f32 v45, v45, v45
    v_and_b32 v45, 0xffff0000, v45
    v_mul_f32 v47, v45, v44
    v_fma_f32 v33, -v47, v46, v45
    v_fma_f32 v33, v33, v44, v47
    v_sub_f32 v45, v34, v43
    v_cvt_pk_bf16_f32 v45, v45, v45
    v_and_b32 v45, 0xffff0000, v45
    v_mul_f32 v47, v45, v44
    v_fma_f32 v34, -v47, v46, v45
    v_fma_f32 v34, v34, v44, v47
    v_sub_f32 v45, v35, v43
    v_cvt_pk_bf16_f32 v45, v45, v45
    v_and_b32 v45, 0xffff0000, v45
    v_mul_f32 v47, v45, v44
    v_fma_f32 v35, -v47, v46, v45
    v_fma_f32 v35, v35, v44, v47
    v_sub_f32 v45, v36, v43
    v_cvt_pk_bf16_f32 v45, v45, v45
    v_and_b32 v45, 0xffff0000, v45
    v_mul_f32 v47, v45, v44
    v_fma_f32 v36, -v47, v46, v45
    v_fma_f32 v36, v36, v44, v47
    v_sub_f32 v45, v37, v43
    v_cvt_pk_bf16_f32 v45, v45, v45
    v_and_b32 v45, 0xffff0000, v45
    v_mul_f32 v47, v45, v44
    v_fma_f32 v37, -v47, v46, v45
    v_fma_f32 v37, v37, v44, v47
    s_mul_i32 s33, s53, 1152
    s_add_u32 s33, s33, 140288
    v_lshl_add_u32 v9, v1, 2, s33
    v_cvt_pk_bf16_f32 v28, v28, v29
    v_cvt_pk_bf16_f32 v30, v30, v31
    v_cvt_pk_bf16_f32 v32, v32, v33
    v_cvt_pk_bf16_f32 v34, v34, v35
    v_cvt_pk_bf16_f32 v36, v36, v37
    ds_write_b32 v9, v28 offset:0
    ds_write_b32 v9, v30 offset:256
    ds_write_b32 v9, v32 offset:512
    ds_write_b32 v9, v34 offset:768
    s_mov_b64 s[42:43], exec
    s_mov_b64 exec, s[44:45]
    ds_write_b32 v9, v36 offset:1024
    s_mov_b64 exec, s[42:43]
T_NOLN_19:
    s_mul_i32 s30, s2, 911
    s_lshr_b32 s30, s30, 16
    s_mul_i32 s31, s30, 72
    s_sub_u32 s31, s2, s31
    s_and_b32 s32, s3, 3
    v_mov_b32 v8, s32
    v_lshrrev_b32 v4, 4, v1
    v_bfe_u32 v5, v1, 2, 2
    v_lshl_add_u32 v4, v4, 3, v5
    v_bfe_u32 v5, v4, 1, 1
    v_bfe_u32 v6, v4, 3, 1
    v_lshl_or_b32 v5, v6, 1, v5
    v_xor_b32 v5, v5, v8
    v_lshlrev_b32 v5, 5, v5
    s_mov_b32 s50, 128
    v_mul_lo_u32 v48, v4, s50
    v_add_u32 v48, v48, v5
    v_and_b32 v5, 3, v1
    v_lshl_add_u32 v48, v5, 3, v48
    v_add_u32 v48, 0x10800, v48
    v_add_u32 v4, 4, v4
    v_bfe_u32 v5, v4, 1, 1
    v_bfe_u32 v6, v4, 3, 1
    v_lshl_or_b32 v5, v6, 1, v5
    v_xor_b32 v5, v5, v8
    v_lshlrev_b32 v5, 5, v5
    s_mov_b32 s50, 128
    v_mul_lo_u32 v49, v4, s50
    v_add_u32 v49, v49, v5
    v_and_b32 v5, 3, v1
    v_lshl_add_u32 v49, v5, 3, v49
    v_add_u32 v49, 0x10800, v49
    s_lshr_b32 s33, s3, 2
    s_mul_i32 s34, s33, 24576
    v_add_u32 v48, s34, v48
    v_add_u32 v49, s34, v49
    v_and_b32 v50, 15, v1
    v_min_u32 v50, 1, v50
    s_mov_b32 s50, 1152
    v_mul_lo_u32 v50, v50, s50
    v_lshrrev_b32 v4, 4, v1
    v_lshl_add_u32 v50, v4, 4, v50
    v_add_u32 v50, 0x22400, v50
    s_mul_i32 s34, s30, 384
    v_add_u32 v50, s34, v50
    s_waitcnt vmcnt(0) lgkmcnt(0)
    s_barrier
    s_cmp_ge_u32 s2, 216
    s_cbranch_scc1 T_NOG_22
    ds_read_b128 v[64:67], v50 offset:0
    ds_read_b64_tr_b16 v[96:97], v48 offset:0
    ds_read_b64_tr_b16 v[98:99], v49 offset:0
    ds_read_b128 v[68:71], v50 offset:64
    ds_read_b64_tr_b16 v[100:101], v48 offset:4096
    ds_read_b64_tr_b16 v[102:103], v49 offset:4096
    ds_read_b128 v[72:75], v50 offset:128
    ds_read_b64_tr_b16 v[104:105], v48 offset:8192
    ds_read_b64_tr_b16 v[106:107], v49 offset:8192
    ds_read_b128 v[76:79], v50 offset:192
    ds_read_b64_tr_b16 v[108:109], v48 offset:12288
    ds_read_b64_tr_b16 v[110:111], v49 offset:12288
    ds_read_b128 v[80:83], v50 offset:256
    ds_read_b64_tr_b16 v[112:113], v48 offset:16384
    ds_read_b64_tr_b16 v[114:115], v49 offset:16384
    ds_read_b128 v[84:87], v50 offset:320
    ds_read_b64_tr_b16 v[116:117], v48 offset:20480
    ds_read_b64_tr_b16 v[118:119], v49 offset:20480
    s_waitcnt lgkmcnt(15)
    v_mfma_f32_16x16x32_bf16 v[52:55], v[64:67], v[96:99], 0
    s_waitcnt lgkmcnt(12)
    v_mfma_f32_16x16x32_bf16 v[52:55], v[68:71], v[100:103], v[52:55]
    s_waitcnt lgkmcnt(9)
    v_mfma_f32_16x16x32_bf16 v[52:55], v[72:75], v[104:107], v[52:55]
    s_waitcnt lgkmcnt(6)
    v_mfma_f32_16x16x32_bf16 v[52:55], v[76:79], v[108:111], v[52:55]
    s_waitcnt lgkmcnt(3)
    v_mfma_f32_16x16x32_bf16 v[52:55], v[80:83], v[112:115], v[52:55]
    s_waitcnt lgkmcnt(0)
    v_mfma_f32_16x16x32_bf16 v[52:55], v[84:87], v[116:119], v[52:55]
    s_mul_i32 s34, s31, 3072
    s_lshl_b32 s35, s30, 10
    s_add_u32 s34, s34, s35
    s_lshl_b32 s35, s33, 9
    s_add_u32 s34, s34, s35
    s_lshl_b32 s35, s32, 6
    s_add_u32 s34, s34, s35
    s_add_u32 s34, s34, 0x80000
    v_lshlrev_b32 v9, 2, v1
    v_cmp_gt_u32 vcc, 16, v1
    s_and_saveexec_b64 s[42:43], vcc
    s_nop 4
    buffer_store_dword v52, v9, s[24:27], s34 offen sc1
    buffer_store_dword v53, v9, s[24:27], s34 offen offset:256 sc1
    s_mov_b64 exec, s[42:43]
T_NOG_22:
    s_lshl_b32 s32, s28, 7
    s_add_u32 s32, s32, 0x100000
    s_mul_i32 s33, s29, 72
    s_lshl_b32 s34, s3, 4
    s_add_u32 s33, s33, s34
    v_add_u32 v3, s33, v1
    v_add_u32 v3, 0, v3
    v_lshrrev_b32 v32, 5, v3
    v_lshlrev_b32 v32, 12, v32
    v_and_b32 v3, 31, v3
    v_lshl_add_u32 v32, v3, 2, v32
    v_add_u32 v3, s33, v1
    v_add_u32 v3, 576, v3
    v_lshrrev_b32 v33, 5, v3
    v_lshlrev_b32 v33, 12, v33
    v_and_b32 v3, 31, v3
    v_lshl_add_u32 v33, v3, 2, v33
    v_lshrrev_b32 v4, 4, v1
    v_bfe_u32 v5, v1, 2, 2
    v_lshl_add_u32 v4, v4, 3, v5
    v_and_b32 v5, 3, v1
    v_lshlrev_b32 v5, 3, v5
    s_lshl_b32 s33, s3, 5
    s_add_u32 s33, s33, 116736
    v_add_u32 v5, s33, v5
    s_movk_i32 s50, 144
    v_mul_lo_u32 v48, v4, s50
    v_add_u32 v48, v48, v5
    v_add_u32 v6, 128, v4
    v_min_u32 v6, 143, v6
    v_mul_lo_u32 v46, v6, s50
    v_add_u32 v46, v46, v5
    v_add_u32 v6, 132, v4
    v_min_u32 v6, 143, v6
    v_mul_lo_u32 v47, v6, s50
    v_add_u32 v47, v47, v5
    v_and_b32 v50, 15, v1
    v_min_u32 v50, 1, v50
    s_mov_b32 s50, 320
    v_mul_lo_u32 v50, v50, s50
    v_lshrrev_b32 v4, 4, v1
    v_lshl_add_u32 v50, v4, 4, v50
    v_add_u32 v50, 0x22d00, v50
    ds_read_b64_tr_b16 v[96:97], v48 offset:0
    ds_read_b64_tr_b16 v[98:99], v48 offset:576
    ds_read_b64_tr_b16 v[100:101], v48 offset:4608
    ds_read_b64_tr_b16 v[102:103], v48 offset:5184
    ds_read_b64_tr_b16 v[104:105], v48 offset:9216
    ds_read_b64_tr_b16 v[106:107], v48 offset:9792
    ds_read_b64_tr_b16 v[108:109], v48 offset:13824
    ds_read_b64_tr_b16 v[110:111], v48 offset:14400
    ds_read_b64_tr_b16 v[112:113], v46
    ds_read_b64_tr_b16 v[114:115], v47
    s_cmp_ge_u32 s3, 5
    s_cbranch_scc1 T_NOA_23
    v_cmp_le_u32 vcc, 160, v0
    s_nop 1
    v_cndmask_b32 v4, 0, 1, vcc
    v_mul_u32_u24 v5, 160, v4
    v_sub_u32 v5, v0, v5
    v_min_u32 v6, 143, v5
    s_mul_i32 s30, s28, 144
    v_add_u32 v6, s30, v6
    v_lshrrev_b32 v7, 6, v6
    v_and_b32 v6, 63, v6
    s_movk_i32 s50, 3072
    v_mul_lo_u32 v7, v7, s50
    v_lshl_add_u32 v7, v6, 2, v7
    v_lshl_add_u32 v7, v4, 8, v7
    s_mov_b32 s31, 0x80000
    s_mov_b32 s52, 0
T_E5_24:
    s_sleep 6
    buffer_load_dword v8, v7, s[24:27], s31 offen offset:0 sc1
    buffer_load_dword v11, v7, s[24:27], s31 offen offset:512 sc1
    buffer_load_dword v9, v7, s[24:27], s31 offen offset:1024 sc1
    buffer_load_dword v12, v7, s[24:27], s31 offen offset:1536 sc1
    buffer_load_dword v10, v7, s[24:27], s31 offen offset:2048 sc1
    buffer_load_dword v13, v7, s[24:27], s31 offen offset:2560 sc1
    s_waitcnt vmcnt(0)
    v_max3_u32 v16, v8, v9, v10
    v_max3_u32 v16, v16, v11, v12
    v_max_u32 v16, v16, v13
    v_cmp_eq_u32 vcc, -1, v16
    s_add_u32 s52, s52, 1
    s_cmp_gt_u32 s52, 200000
    s_cbranch_scc1 T_E5D_25
    s_cbranch_vccnz T_E5_24
T_E5D_25:
    v_add_f32 v16, v8, v9
    v_add_f32 v16, v16, v10
    v_add_f32 v20, v11, v12
    v_add_f32 v20, v20, v13
    v_cvt_pk_bf16_f32 v16, v16, v16
    v_and_b32 v16, 0xffff0000, v16
    v_cvt_pk_bf16_f32 v20, v20, v20
    v_and_b32 v20, 0xffff0000, v20
    v_mul_f32 v17, 0xbfb8aa3b, v16
    v_exp_f32 v17, v17
    s_nop 0
    v_add_f32 v17, 1.0, v17
    v_rcp_f32 v18, v17
    s_nop 0
    v_mul_f32 v19, v16, v18
    v_fma_f32 v21, -v19, v17, v16
    v_fma_f32 v19, v21, v18, v19
    v_cvt_pk_bf16_f32 v19, v19, v19
    v_and_b32 v19, 0xffff0000, v19
    v_mul_f32 v19, v19, v20
    v_cvt_pk_bf16_f32 v19, v19, v19
    v_cmp_gt_u32 vcc, 144, v5
    s_nop 1
    v_cndmask_b32 v19, 0, v19, vcc
    v_lshlrev_b32 v9, 1, v0
    v_add_u32 v9, 142592, v9
    ds_write_b16 v9, v19
T_NOA_23:
    s_waitcnt lgkmcnt(0)
    s_barrier
    s_cmp_ge_u32 s3, 5
    s_cbranch_scc1 T_NOB_26
    ds_read_b128 v[64:67], v50 offset:0
    ds_read_b128 v[68:71], v50 offset:64
    ds_read_b128 v[72:75], v50 offset:128
    ds_read_b128 v[76:79], v50 offset:192
    ds_read_b128 v[80:83], v50 offset:256
    s_waitcnt lgkmcnt(4)
    v_mfma_f32_16x16x32_bf16 v[52:55], v[64:67], v[96:99], 0
    s_waitcnt lgkmcnt(3)
    v_mfma_f32_16x16x32_bf16 v[52:55], v[68:71], v[100:103], v[52:55]
    s_waitcnt lgkmcnt(2)
    v_mfma_f32_16x16x32_bf16 v[52:55], v[72:75], v[104:107], v[52:55]
    s_waitcnt lgkmcnt(1)
    v_mfma_f32_16x16x32_bf16 v[52:55], v[76:79], v[108:111], v[52:55]
    s_waitcnt lgkmcnt(0)
    v_mfma_f32_16x16x32_bf16 v[52:55], v[80:83], v[112:115], v[52:55]
    s_mov_b32 s47, 0xffff
    s_cmp_eq_u32 s3, 4
    s_cselect_b32 s46, 0xff, s47
    s_mov_b32 s47, 0
    s_mov_b64 exec, s[46:47]
    s_nop 4
    buffer_store_dword v52, v32, s[24:27], s32 offen sc1
    buffer_store_dword v53, v33, s[24:27], s32 offen sc1
    s_mov_b64 exec, -1
T_NOB_26:
    s_cmp_lg_u32 s3, 5
    s_cbranch_scc1 T_FIN
    s_cmp_ge_u32 s2, 36
    s_cbranch_scc1 T_FIN
    s_load_dwordx2 s[4:5], s[0:1], 80
    v_and_b32 v3, 31, v1
    s_lshl_b32 s30, s2, 5
    v_add_u32 v3, s30, v3
    v_lshlrev_b32 v31, 1, v3
    v_lshlrev_b32 v32, 2, v3
    s_mov_b32 s31, 0x10000
    buffer_load_ushort v28, v31, s[12:15], 0 offen
    buffer_load_dword v29, v32, s[24:27], s31 offen sc1
    v_lshlrev_b32 v6, 4, v1
    s_lshl_b32 s31, s2, 12
    s_add_u32 s31, s31, 0x100000
    s_mov_b32 s52, 0
T_F_27:
    s_sleep 6
    buffer_load_dwordx4 v[8:11], v6, s[24:27], s31 offen offset:0 sc1
    buffer_load_dwordx4 v[12:15], v6, s[24:27], s31 offen offset:1024 sc1
    buffer_load_dwordx4 v[16:19], v6, s[24:27], s31 offen offset:2048 sc1
    buffer_load_dwordx4 v[20:23], v6, s[24:27], s31 offen offset:3072 sc1
    s_waitcnt vmcnt(0)
    v_max3_u32 v30, v8, v9, v10
    v_max3_u32 v30, v30, v11, v12
    v_max3_u32 v30, v30, v13, v14
    v_max3_u32 v30, v30, v15, v16
    v_max3_u32 v30, v30, v17, v18
    v_max3_u32 v30, v30, v19, v20
    v_max3_u32 v30, v30, v21, v22
    v_max_u32 v30, v30, v23
    v_cmp_eq_u32 vcc, -1, v30
    s_add_u32 s52, s52, 1
    s_cmp_gt_u32 s52, 200000
    s_cbranch_scc1 T_FD_28
    s_cbranch_vccnz T_F_27
T_FD_28:
    v_add_f32 v8, v8, v12
    v_add_f32 v16, v16, v20
    v_add_f32 v8, v8, v16
    v_add_f32 v9, v9, v13
    v_add_f32 v17, v17, v21
    v_add_f32 v9, v9, v17
    v_add_f32 v10, v10, v14
    v_add_f32 v18, v18, v22
    v_add_f32 v10, v10, v18
    v_add_f32 v11, v11, v15
    v_add_f32 v19, v19, v23
    v_add_f32 v11, v11, v19
    v_add_u32 v7, 143232, v6
    ds_write_b128 v7, v[8:11]
    v_and_b32 v7, 31, v1
    v_lshlrev_b32 v7, 2, v7
    v_add_u32 v7, 143232, v7
    s_waitcnt lgkmcnt(0)
    ds_read_b32 v8, v7 offset:0
    ds_read_b32 v9, v7 offset:128
    ds_read_b32 v10, v7 offset:256
    ds_read_b32 v11, v7 offset:384
    ds_read_b32 v12, v7 offset:512
    ds_read_b32 v13, v7 offset:640
    ds_read_b32 v14, v7 offset:768
    ds_read_b32 v15, v7 offset:896
    s_waitcnt lgkmcnt(0)
    v_add_f32 v8, v8, v9
    v_add_f32 v10, v10, v11
    v_add_f32 v12, v12, v13
    v_add_f32 v14, v14, v15
    v_add_f32 v8, v8, v10
    v_add_f32 v12, v12, v14
    v_add_f32 v8, v8, v12
    s_mov_b32 s16, s4
    s_and_b32 s17, s5, 0xffff
    s_mov_b32 s18, 0x900
    s_mov_b32 s19, 0x20000
    v_cvt_pk_bf16_f32 v8, v8, v8
    v_and_b32 v8, 0xffff0000, v8
    v_lshlrev_b32 v28, 16, v28
    v_cvt_pk_bf16_f32 v29, v29, v29
    v_and_b32 v29, 0xffff0000, v29
    v_add_f32 v28, v28, v29
    v_cvt_pk_bf16_f32 v28, v28, v28
    v_and_b32 v28, 0xffff0000, v28
    v_add_f32 v28, v28, v8
    v_cvt_pk_bf16_f32 v28, v28, v28
    s_mov_b64 exec, 0xffffffff
    buffer_store_short v28, v31, s[16:19], 0 offen
    s_mov_b64 exec, -1
T_FIN:
T_END:
    s_endpgm
.section .rodata,"a"
.p2align 6
.amdhsa_kernel k1_kernel
  .amdhsa_next_free_vgpr 128
  .amdhsa_next_free_sgpr 102
  .amdhsa_accum_offset 128
  .amdhsa_group_segment_fixed_size 0
  .amdhsa_kernarg_size 104
  .amdhsa_user_sgpr_count 2
  .amdhsa_user_sgpr_kernarg_segment_ptr 1
  .amdhsa_system_sgpr_workgroup_id_x 1
  .amdhsa_float_denorm_mode_32 3
.end_amdhsa_kernel
.p2align 6
.amdhsa_kernel k2_kernel
  .amdhsa_next_free_vgpr 264
  .amdhsa_next_free_sgpr 102
  .amdhsa_accum_offset 256
  .amdhsa_group_segment_fixed_size 0
  .amdhsa_kernarg_size 104
  .amdhsa_user_sgpr_count 2
  .amdhsa_user_sgpr_kernarg_segment_ptr 1
  .amdhsa_system_sgpr_workgroup_id_x 1
  .amdhsa_float_denorm_mode_32 3
.end_amdhsa_kernel
.p2align 6
.amdhsa_kernel t_kernel
  .amdhsa_next_free_vgpr 208
  .amdhsa_next_free_sgpr 102
  .amdhsa_accum_offset 208
  .amdhsa_group_segment_fixed_size 0
  .amdhsa_kernarg_size 104
  .amdhsa_user_sgpr_count 2
  .amdhsa_user_sgpr_kernarg_segment_ptr 1
  .amdhsa_system_sgpr_workgroup_id_x 1
  .amdhsa_float_denorm_mode_32 3
.end_amdhsa_kernel
```
